```python
import torch

def _softmax(x, axis=-1):
    return torch.softmax(x, dim=axis)
def _gelu(x):
    return torch.nn.functional.gelu(x, approximate="tanh")
def _silu(x):
    return torch.nn.functional.silu(x)
def _sigmoid(x):
    return torch.sigmoid(x)
def _layernorm(x, axis=-1, eps=1e-5):
    m = x.mean(dim=axis, keepdim=True)
    v = x.var(dim=axis, keepdim=True, unbiased=False)
    return (x - m) / torch.sqrt(v + eps)
def _scatter_add(tgt, idx, src, axis=0):
    return tgt.clone().index_add_(axis, idx, src)
def _segment_sum(src, seg, n):
    out = torch.zeros((n,) + src.shape[1:], dtype=src.dtype)
    return out.index_add_(0, seg, src)
def _pad(x, pw):
    flat = tuple(v for pair in reversed(pw) for v in pair)
    return torch.nn.functional.pad(x, flat)

kernel_name = 'standalone__modern_conv_block_replknet__vision'

def setup_inputs():

    _w = (lambda a: (lambda t: t.to(torch.bfloat16) if t.is_floating_point() else t)(torch.as_tensor(a)))
    H = W = 224
    C = 96
    K = 3
    return {
        "x": _w((lambda *s: torch.randn(*s, dtype=torch.bfloat16) * 0.05)(1, H, W, C)),
        "dw_large": _w((lambda *s: torch.randn(*s, dtype=torch.bfloat16) * 0.4)(K, K, C) * (1.0 / K)),
        "dw_small": _w((lambda *s: torch.randn(*s, dtype=torch.bfloat16) * 0.4)(5, 5, C) * 0.2),
        "w1": _w((lambda *s: torch.randn(*s, dtype=torch.bfloat16) * 0.4)(C, 4 * C) * (C ** -0.5)),
        "w2": _w((lambda *s: torch.randn(*s, dtype=torch.bfloat16) * 0.1)(4 * C, C) * ((4 * C) ** -0.5)),
    }

def reference(x, dw_large, dw_small, w1, w2):
    B, H, W, C = x.shape
    Kl = dw_large.shape[0]
    pl = (Kl - 1) // 2
    xpl = _pad(x, ((0,0),(pl,pl),(pl,pl),(0,0)))
    out = torch.zeros_like(x)
    for i in range(Kl):
        for j in range(Kl):
            out = out + xpl[:, i:i+H, j:j+W, :] * dw_large[i, j][None, None, None, :]
    Ks = dw_small.shape[0]
    ps = (Ks - 1) // 2
    xps = _pad(x, ((0,0),(ps,ps),(ps,ps),(0,0)))
    for i in range(Ks):
        for j in range(Ks):
            out = out + xps[:, i:i+H, j:j+W, :] * dw_small[i, j][None, None, None, :]
    h = _layernorm(out, axis=-1)
    h = _gelu(torch.einsum('bhwc,ce->bhwe', h, w1))
    h = torch.einsum('bhwe,ec->bhwc', h, w2)
    return x + h
```

```asm
; @launch grid=(256,1,1) block=(512,1,1) lds=163840
.amdgcn_target "amdgcn-amd-amdhsa--gfx950"
.text
.globl standalone__modern_conv_block_replknet__vision_kernel
.p2align 8
.type standalone__modern_conv_block_replknet__vision_kernel,@function
standalone__modern_conv_block_replknet__vision_kernel:
    s_load_dwordx4 s[4:7], s[0:1], 0
    s_load_dwordx4 s[8:11], s[0:1], 16
    s_load_dwordx4 s[12:15], s[0:1], 32
    s_getpc_b64 s[100:101]
L_pc:
    v_lshrrev_b32 v250, 6, v0
    s_cmp_ge_u32 s2, 256
    s_cbranch_scc1 L_end
    v_and_b32 v255, 63, v0
    s_lshr_b32 s44, s2, 3
    v_readfirstlane_b32 s40, v250
    s_and_b32 s45, s2, 1
    s_add_u32 s45, s45, s44
    s_cmp_ge_u32 s45, 32
    s_cbranch_scc1 L_end
    s_cmp_lt_u32 s40, 4
    s_cbranch_scc1 L_e1
    s_setprio 3
L_e1:
    s_and_b32 s43, s2, 3
    v_mul_u32_u24 v250, 43, v255
    s_mul_i32 s43, s43, 63
    s_add_u32 s43, s43, 1
    v_lshrrev_b32 v250, 9, v250
    s_lshr_b32 s43, s43, 1
    s_add_u32 s43, s43, s44
    v_mad_i32_i24 v251, v250, -12, v255
    s_mul_i32 s44, s43, 9363
    s_lshr_b32 s44, s44, 16
    s_and_b32 s3, s40, 3
    s_bfe_u32 s45, s2, 0x10002
    s_sub_u32 s45, s45, s44
    s_mul_i32 s45, s45, 7
    v_mad_u32_u24 v250, s3, 5, v250
    s_add_u32 s43, s43, s45
    s_lshl_b32 s42, s43, 4
    v_bfe_u32 v252, v250, 2, 2
    s_mul_i32 s47, s44, 815584
    v_xor_b32 v251, v251, v252
    s_add_u32 s47, s47, 29128
    s_lshr_b32 s41, s47, 16
    v_add3_u32 v250, v250, s42, -2
    s_mov_b32 s99, 43008
    v_mul_u32_u24 v252, 192, v250
    s_sub_u32 s44, s41, 2
    v_cmp_gt_u32 vcc, 224, v250
    s_mul_i32 s44, s44, s99
    v_lshl_add_u32 v252, v251, 4, v252
    v_mov_b32 v254, 1073741824
    s_mul_i32 s56, s3, 960
    v_cndmask_b32 v203, v254, v252, vcc
    s_mov_b32 s18, 9633792
    s_mov_b32 s19, 0x00020000
    v_add_u32 v203, s44, v203
    s_cmp_lt_u32 s40, 4
    s_cbranch_scc1 L_F0
    s_add_u32 m0, s56, 73728
    s_movk_i32 s97, 3840
    s_mov_b32 exec_hi, 0x0fffffff
    s_waitcnt lgkmcnt(0)
    s_mov_b64 s[16:17], s[4:5]
    buffer_load_dwordx4 v203, s[16:19], 0 offen lds
    s_add_u32 m0, m0, s97
    v_add_u32 v203, s99, v203
    buffer_load_dwordx4 v203, s[16:19], 0 offen lds
    v_lshlrev_b32 v253, 4, v255
    s_mov_b32 s96, m0
    s_mov_b32 s26, 4800
    s_mov_b32 s27, 0x00020000
    s_mul_i32 s46, s3, 976
    s_mov_b64 s[24:25], s[8:9]
    s_add_u32 m0, s46, 146096
    s_mov_b32 s23, 0x00020000
    buffer_load_dwordx4 v253, s[24:27], s56 offen lds
    s_mul_i32 s45, s3, 576
    s_sub_u32 s45, s45, 192
    s_add_u32 s44, s46, 141216
    s_cmp_eq_u32 s3, 3
    s_cselect_b32 s22, s26, 1728
    s_cselect_b32 s45, 3840, s45
    s_cselect_b32 m0, 150000, s44
    s_cselect_b64 s[20:21], s[8:9], s[6:7]
    s_cselect_b32 exec_lo, -1, 0xfffff000
    s_cselect_b32 exec_hi, -1, 0xffff
    v_add_u32 v254, s45, v253
    s_mov_b32 exec_lo, -1
    s_mov_b32 exec_hi, 0x0fffffff
    buffer_load_dwordx4 v254, s[20:23], 0 offen lds
    s_mov_b32 m0, s96
    s_add_u32 m0, m0, s97
    v_add_u32 v203, s99, v203
    buffer_load_dwordx4 v203, s[16:19], 0 offen lds
    s_add_u32 m0, m0, s97
    v_add_u32 v203, s99, v203
    buffer_load_dwordx4 v203, s[16:19], 0 offen lds
    s_add_u32 m0, m0, s97
    v_add_u32 v203, s99, v203
    buffer_load_dwordx4 v203, s[16:19], 0 offen lds
    s_add_u32 m0, m0, s97
    v_add_u32 v203, s99, v203
    buffer_load_dwordx4 v203, s[16:19], 0 offen lds
    s_add_u32 m0, m0, s97
    v_add_u32 v203, s99, v203
    buffer_load_dwordx4 v203, s[16:19], 0 offen lds
    s_add_u32 m0, m0, s97
    v_add_u32 v203, s99, v203
    buffer_load_dwordx4 v203, s[16:19], 0 offen lds
    s_setprio 0
    s_branch L_L
L_F0:
    s_add_u32 s47, s47, 815584
    s_lshr_b32 s47, s47, 16
    s_sub_u32 s47, s47, s41
    s_cmp_eq_u32 s47, 13
    s_cbranch_scc1 L_nopf
    s_bfe_u32 s46, s2, 0x20003
    s_lshl_b32 s46, s46, 2
    s_add_u32 s46, s46, s3
    s_mul_i32 s46, s46, 2560
    v_lshl_add_u32 v252, v255, 7, s46
    v_min_u32 v252, L_end-L_pc, v252
    v_mov_b32 v253, s101
    v_add_co_u32 v252, vcc, s100, v252
    s_mov_b64 exec, 0xfffff
    s_nop 0
    v_addc_co_u32 v253, vcc, 0, v253, vcc
    global_load_dword v202, v[252:253], off
    s_mov_b64 exec, -1
L_nopf:
    s_setprio 2
    v_lshlrev_b32 v244, 4, v255
    s_mul_i32 s57, s3, 6144
    s_mov_b32 s62, 49152
    s_cmp_eq_u32 s3, 1
    s_cbranch_scc1 L_ct1
    s_cmp_eq_u32 s3, 2
    s_cbranch_scc1 L_ct2
    s_cmp_eq_u32 s3, 3
    s_cbranch_scc1 L_ct3
    v_and_b32 v250, 15, v255
    v_bfe_u32 v251, v255, 4, 1
    v_lshrrev_b32 v253, 5, v255
    v_lshl_add_u32 v252, v251, 1, v253
    v_add_u32 v252, v250, v252
    v_bfe_u32 v254, v252, 2, 2
    v_mul_u32_u24 v252, 192, v252
    v_lshl_add_u32 v4, v254, 4, v252
    v_add_u32 v4, 73728, v4
    v_add_u32 v252, 4, v250
    v_bfe_u32 v254, v252, 2, 2
    v_mul_u32_u24 v252, 192, v252
    v_lshl_add_u32 v6, v254, 4, v252
    v_add_u32 v6, 73728, v6
    v_lshrrev_b32 v252, 4, v255
    v_mul_u32_u24 v252, 3840, v252
    v_add_u32 v5, v6, v252
    v_bfe_u32 v254, v255, 2, 2
    v_and_b32 v252, 31, v255
    v_mul_u32_u24 v252, 192, v252
    v_lshl_add_u32 v252, v254, 4, v252
    v_bfe_u32 v254, v255, 1, 1
    v_xor_b32 v253, v253, v254
    v_lshl_add_u32 v7, v253, 3, v252
    ds_write_b128 v244, v[4:7] offset:0
    v_add_u32 v250, 0, v255
    v_mul_u32_u24 v252, 171, v250
    v_bfe_u32 v252, v252, 12, 2
    v_xor_b32 v250, v250, v252
    v_lshlrev_b32 v8, 4, v250
    v_add_u32 v250, 64, v255
    v_mul_u32_u24 v252, 171, v250
    v_bfe_u32 v252, v252, 12, 2
    v_xor_b32 v250, v250, v252
    v_lshlrev_b32 v9, 4, v250
    v_add_u32 v250, 128, v255
    v_mul_u32_u24 v252, 171, v250
    v_bfe_u32 v252, v252, 12, 2
    v_xor_b32 v250, v250, v252
    v_lshlrev_b32 v10, 4, v250
    v_and_b32 v250, 3, v255
    v_lshlrev_b32 v11, 2, v250
    v_add_u32 v11, 163584, v11
    ds_write_b128 v244, v[8:11] offset:2048
    v_add_u32 v250, 139264, v244
    v_mov_b64 v[0:1], 0
    v_mov_b64 v[2:3], 0
    ds_write_b128 v250, v[0:3] offset:0
    ds_write_b128 v250, v[0:3] offset:928
    ds_write_b128 v250, v[0:3] offset:4880
    ds_write_b128 v250, v[0:3] offset:5808
    ds_write_b128 v250, v[0:3] offset:11712
    ds_write_b128 v250, v[0:3] offset:12736
    ds_write_b128 v250, v[0:3] offset:13616
    s_branch L_ctj
L_ct1:
    v_and_b32 v250, 3, v255
    v_mul_u32_u24 v7, 0x5555, v250
    s_mov_b32 s45, 139264
    v_bfe_u32 v251, v255, 1, 1
    v_lshl_add_u32 v254, v251, 3, s45
    v_and_b32 v250, 1, v255
    v_lshrrev_b32 v251, 5, v255
    v_sub_u32 v251, v251, v250
    v_bfe_u32 v252, v255, 2, 1
    v_mad_i32_i24 v251, v252, -6, v251
    v_add_u32 v251, 7, v251
    v_mul_u32_u24 v251, 976, v251
    v_bfe_u32 v253, v255, 3, 1
    v_add_u32 v6, -1, v253
    v_bfe_u32 v252, v255, 4, 1
    v_lshl_add_u32 v252, v253, 1, v252
    v_mul_u32_u24 v252, 192, v252
    v_add3_u32 v4, v251, v252, v254
    v_lshrrev_b32 v251, 4, v255
    v_lshl_add_u32 v252, v251, 1, v253
    v_sub_u32 v252, v252, v250
    v_add_u32 v252, 5, v252
    v_mul_u32_u24 v252, 976, v252
    v_mov_b32 v5, s45
    s_mov_b32 exec_lo, 0x0f0f0f0f
    s_mov_b32 exec_hi, 0x0f0f0f0f
    v_add_u32 v252, 768, v252
    v_add_u32 v5, v252, v254
    s_mov_b64 exec, -1
    ds_write_b128 v244, v[4:7] offset:1024
    v_lshrrev_b32 v250, 3, v255
    v_mul_u32_u24 v250, 768, v250
    v_bfe_u32 v251, v255, 4, 1
    v_lshlrev_b32 v251, 2, v251
    v_and_b32 v252, 7, v255
    v_xor_b32 v251, v251, v252
    v_lshl_add_u32 v8, v251, 4, v250
    v_mov_b32 v9, v244
    v_mov_b32 v10, v244
    v_mov_b32 v11, v244
    s_mov_b32 exec_lo, 0xffff0000
    v_xor_b32 v11, 32, v244
    s_mov_b32 exec_lo, 0
    s_mov_b32 exec_hi, 0xffff0000
    v_xor_b32 v9, 32, v244
    s_mov_b32 exec_lo, -1
    s_mov_b32 exec_hi, 0
    v_xor_b32 v10, 32, v244
    s_mov_b64 exec, -1
    ds_write_b128 v244, v[8:11] offset:7168
    s_branch L_ctj
L_ct2:
    v_lshrrev_b32 v254, 5, v255
    v_bfe_u32 v250, v255, 2, 2
    v_bfe_u32 v251, v255, 4, 1
    v_and_b32 v252, 3, v255
    v_lshl_add_u32 v253, v254, 4, v250
    v_lshlrev_b32 v253, 7, v253
    v_lshl_add_u32 v253, v251, 5, v253
    v_lshl_add_u32 v253, v252, 3, v253
    v_bfe_u32 v252, v255, 3, 1
    v_lshl_add_u32 v4, v252, 6, v253
    v_xor_b32 v5, 64, v4
    v_xor_b32 v6, 32, v4
    v_xor_b32 v7, 0x60, v4
    ds_write_b128 v244, v[4:7] offset:3072
    v_lshl_add_u32 v253, v254, 2, v250
    v_mul_u32_u24 v253, 192, v253
    v_lshl_add_u32 v253, v251, 4, v253
    v_and_b32 v252, 1, v255
    v_xor_b32 v252, v252, v254
    v_lshl_add_u32 v253, v252, 5, v253
    v_bfe_u32 v252, v255, 1, 1
    v_lshl_add_u32 v8, v252, 3, v253
    v_and_b32 v253, 15, v255
    v_mul_u32_u24 v253, 192, v253
    v_add_u32 v16, 2, v255
    v_bfe_u32 v16, v16, 2, 2
    v_bfe_u32 v17, v255, 1, 2
    v_lshl_add_u32 v18, v251, 3, v253
    v_xor_b32 v12, v254, v17
    v_lshl_add_u32 v12, v12, 4, v18
    v_xor_b32 v13, v254, v16
    v_lshl_add_u32 v13, v13, 4, v18
    v_lshlrev_b32 v254, 1, v254
    v_xor_b32 v250, v254, v250
    v_lshl_add_u32 v250, v250, 4, v253
    v_lshl_add_u32 v250, v252, 3, v250
    v_mul_u32_u24 v252, 12288, v251
    v_add_u32 v9, v250, v252
    v_xor_b32 v16, v254, v16
    v_lshl_add_u32 v16, v16, 4, v253
    v_mul_u32_u24 v252, 15360, v251
    v_add_u32 v10, v16, v252
    v_xor_b32 v17, v254, v17
    v_lshl_add_u32 v17, v17, 4, v253
    v_mul_u32_u24 v252, 3072, v251
    v_add_u32 v11, v17, v252
    v_mov_b64 v[14:15], 0
    ds_write_b128 v244, v[8:11] offset:4096
    ds_write_b128 v244, v[12:15] offset:9216
    s_branch L_ctj
L_ct3:
    v_and_b32 v251, 1, v255
    v_lshlrev_b32 v251, 4, v251
    v_mov_b32 v252, 0x3f80
    v_lshlrev_b32 v251, v251, v252
    v_mov_b64 v[4:5], 0
    v_mov_b64 v[6:7], 0
    v_mov_b64 v[8:9], 0
    v_mov_b64 v[10:11], 0
    s_mov_b32 exec_lo, 0x3
    s_mov_b32 exec_hi, 0x30
    v_mov_b32 v4, v251
    s_mov_b32 exec_lo, 0xc
    s_mov_b32 exec_hi, 0xc0
    v_mov_b32 v5, v251
    s_mov_b32 exec_lo, 0x300
    s_mov_b32 exec_hi, 0x3000
    v_mov_b32 v6, v251
    s_mov_b32 exec_lo, 0xc00
    s_mov_b32 exec_hi, 0xc000
    v_mov_b32 v7, v251
    s_mov_b32 exec_lo, 0x30000
    s_mov_b32 exec_hi, 0x300000
    v_mov_b32 v8, v251
    s_mov_b32 exec_lo, 0xc0000
    s_mov_b32 exec_hi, 0xc00000
    v_mov_b32 v9, v251
    s_mov_b32 exec_lo, 0x3000000
    s_mov_b32 exec_hi, 0x30000000
    v_mov_b32 v10, v251
    s_mov_b32 exec_lo, 0xc000000
    s_mov_b32 exec_hi, 0xc0000000
    v_mov_b32 v11, v251
    s_mov_b64 exec, -1
    ds_write_b128 v244, v[4:7] offset:5120
    ds_write_b128 v244, v[8:11] offset:6144
    v_lshrrev_b32 v254, 4, v255
    v_bfe_u32 v250, v255, 2, 2
    v_and_b32 v252, 3, v255
    v_bfe_u32 v251, v255, 4, 1
    v_lshlrev_b32 v252, 3, v252
    v_lshl_add_u32 v252, v251, 5, v252
    v_lshl_add_u32 v253, v254, 3, v250
    v_lshl_add_u32 v253, v253, 7, v252
    v_bfe_u32 v251, v255, 3, 1
    v_lshl_add_u32 v12, v251, 6, v253
    v_lshl_add_u32 v253, v254, 2, v250
    v_mul_u32_u24 v253, 192, v253
    v_add_u32 v13, v253, v252
    v_xor_b32 v250, v254, v250
    v_and_b32 v253, 15, v255
    v_mul_u32_u24 v253, 192, v253
    v_lshl_add_u32 v14, v250, 4, v253
    v_bfe_u32 v251, v255, 1, 1
    v_lshl_add_u32 v15, v251, 3, v14
    ds_write_b128 v244, v[12:15] offset:8192
L_ctj:
    s_waitcnt lgkmcnt(0)
    s_add_u32 m0, s56, 100608
    s_movk_i32 s97, 3840
    v_add_u32 v203, 301056, v203
    s_mov_b64 s[16:17], s[4:5]
    s_mov_b32 exec_hi, 0x0fffffff
    s_add_u32 m0, m0, s97
    v_add_u32 v203, s99, v203
    buffer_load_dwordx4 v203, s[16:19], 0 offen lds
    s_add_u32 m0, m0, s97
    v_add_u32 v203, s99, v203
    buffer_load_dwordx4 v203, s[16:19], 0 offen lds
    s_add_u32 m0, m0, s97
    v_add_u32 v203, s99, v203
    buffer_load_dwordx4 v203, s[16:19], 0 offen lds
    s_add_u32 m0, m0, s97
    v_add_u32 v203, s99, v203
    buffer_load_dwordx4 v203, s[16:19], 0 offen lds
    s_mov_b32 exec_hi, -1
    v_mov_b64 v[0:1], 0
    v_mov_b64 v[2:3], 0
    v_mov_b64 v[4:5], 0
    v_mov_b64 v[6:7], 0
    v_mov_b64 v[8:9], 0
    v_mov_b64 v[10:11], 0
    v_mov_b64 v[12:13], 0
    v_mov_b64 v[14:15], 0
    v_mov_b64 v[16:17], 0
    v_mov_b64 v[18:19], 0
    v_mov_b64 v[20:21], 0
    v_mov_b64 v[22:23], 0
    v_mov_b64 v[24:25], 0
    v_mov_b64 v[26:27], 0
    v_mov_b64 v[28:29], 0
    v_mov_b64 v[30:31], 0
    v_mov_b64 v[32:33], 0
    v_mov_b64 v[34:35], 0
    v_mov_b64 v[36:37], 0
    v_mov_b64 v[38:39], 0
    v_mov_b64 v[40:41], 0
    v_mov_b64 v[42:43], 0
    v_mov_b64 v[44:45], 0
    v_mov_b64 v[46:47], 0
    s_lshl_b32 s43, s40, 2
    s_add_u32 s43, s43, 163584
    v_mov_b32 v248, s43
    ds_write_b32 v248, v0
    s_mul_i32 s58, s3, 18432
    s_mul_i32 s59, s3, 3072
    s_mov_b64 s[28:29], s[10:11]
    s_mov_b32 s30, 73728
    s_mov_b32 s31, 0x00020000
    s_mov_b64 s[32:33], s[12:13]
    s_mov_b32 s34, 73728
    s_mov_b32 s35, 0x00020000
    s_mov_b64 s[36:37], s[14:15]
    s_mov_b32 s38, 9633792
    s_mov_b32 s39, 0x00020000
    s_mov_b32 s48, 0x3eeff558
    s_mov_b32 s49, 0x3eeff558
    s_mov_b32 s50, 0xc09d30fc
    s_mov_b32 s51, 0xc09d30fc
    s_add_u32 s43, s3, s41
    s_mul_i32 s43, s43, 224
    s_add_u32 s43, s43, s42
    s_mul_i32 s60, s43, 192
    s_waitcnt lgkmcnt(0)
    s_barrier
    ds_read_b128 v[196:199], v244 offset:1024
    ds_read_b128 v[192:195], v244 offset:0
    ds_read_b128 v[240:243], v244 offset:2048
    ds_read_b128 v[236:239], v244 offset:3072
    ds_read_b128 v[52:55], v244 offset:4096
    ds_read_b128 v[228:231], v244 offset:5120
    ds_read_b128 v[232:235], v244 offset:6144
    ds_read_b128 v[56:59], v244 offset:7168
    s_waitcnt lgkmcnt(6)
    s_lshl_b32 s43, s3, 4
    v_add_u32 v196, s43, v196
    v_add_u32 v197, s43, v197
    v_xor_b32 v192, s43, v192
    v_xor_b32 v193, s43, v193
    v_xor_b32 v194, s43, v194
    v_xor_b32 v195, s43, v195
    v_add_u32 v195, s62, v195
    ds_read_b64_tr_b16 v[86:87], v196 offset:0
    ds_read_b64_tr_b16 v[90:91], v196 offset:1952
    ds_read_b64_tr_b16 v[94:95], v196 offset:3904
    ds_read_b64_tr_b16 v[98:99], v197 offset:1952
    ds_read_b64_tr_b16 v[102:103], v197 offset:0
    ds_read_b64_tr_b16 v[106:107], v196 offset:64
    ds_read_b64_tr_b16 v[110:111], v196 offset:2016
    ds_read_b64_tr_b16 v[114:115], v196 offset:3968
    ds_read_b64_tr_b16 v[118:119], v197 offset:2016
    ds_read_b64_tr_b16 v[122:123], v197 offset:64
    ds_read_b64_tr_b16 v[126:127], v196 offset:128
    ds_read_b64_tr_b16 v[130:131], v196 offset:2080
    ds_read_b64_tr_b16 v[134:135], v196 offset:4032
    ds_read_b64_tr_b16 v[138:139], v197 offset:2080
    ds_read_b64_tr_b16 v[142:143], v197 offset:128
    s_mov_b32 exec_hi, 0x0fffffff
    s_add_u32 m0, m0, s97
    v_add_u32 v203, s99, v203
    buffer_load_dwordx4 v203, s[16:19], 0 offen lds
    s_add_u32 m0, m0, s97
    v_add_u32 v203, s99, v203
    buffer_load_dwordx4 v203, s[16:19], 0 offen lds
    s_add_u32 m0, m0, s97
    v_add_u32 v203, s99, v203
    buffer_load_dwordx4 v203, s[16:19], 0 offen lds
    s_add_u32 m0, m0, s97
    v_add_u32 v203, s99, v203
    buffer_load_dwordx4 v203, s[16:19], 0 offen lds
    s_add_u32 m0, m0, s97
    v_add_u32 v203, s99, v203
    buffer_load_dwordx4 v203, s[16:19], 0 offen lds
    s_mov_b32 exec_hi, -1
    s_waitcnt lgkmcnt(0)
    v_and_b32 v84, v198, v86
    v_bfi_b32 v85, v198, 0, v86
    v_and_b32 v86, v198, v87
    v_bfi_b32 v87, v198, 0, v87
    v_and_b32 v88, v198, v90
    v_bfi_b32 v89, v198, 0, v90
    v_and_b32 v90, v198, v91
    v_bfi_b32 v91, v198, 0, v91
    v_and_b32 v92, v198, v94
    v_bfi_b32 v93, v198, 0, v94
    v_and_b32 v94, v198, v95
    v_bfi_b32 v95, v198, 0, v95
    v_and_b32 v96, v198, v98
    v_bfi_b32 v97, v198, 0, v98
    v_and_b32 v98, v198, v99
    v_bfi_b32 v99, v198, 0, v99
    v_and_b32 v100, v198, v102
    v_bfi_b32 v101, v198, 0, v102
    v_and_b32 v102, v198, v103
    v_bfi_b32 v103, v198, 0, v103
    v_and_b32 v104, v198, v106
    v_bfi_b32 v105, v198, 0, v106
    v_and_b32 v106, v198, v107
    v_bfi_b32 v107, v198, 0, v107
    v_and_b32 v108, v198, v110
    v_bfi_b32 v109, v198, 0, v110
    v_and_b32 v110, v198, v111
    v_bfi_b32 v111, v198, 0, v111
    v_and_b32 v112, v198, v114
    v_bfi_b32 v113, v198, 0, v114
    v_and_b32 v114, v198, v115
    v_bfi_b32 v115, v198, 0, v115
    v_and_b32 v116, v198, v118
    v_bfi_b32 v117, v198, 0, v118
    v_and_b32 v118, v198, v119
    v_bfi_b32 v119, v198, 0, v119
    v_and_b32 v120, v198, v122
    v_bfi_b32 v121, v198, 0, v122
    v_and_b32 v122, v198, v123
    v_bfi_b32 v123, v198, 0, v123
    v_and_b32 v124, v198, v126
    v_bfi_b32 v125, v198, 0, v126
    v_and_b32 v126, v198, v127
    v_bfi_b32 v127, v198, 0, v127
    v_and_b32 v128, v198, v130
    v_bfi_b32 v129, v198, 0, v130
    v_and_b32 v130, v198, v131
    v_bfi_b32 v131, v198, 0, v131
    v_and_b32 v132, v198, v134
    v_bfi_b32 v133, v198, 0, v134
    v_and_b32 v134, v198, v135
    v_bfi_b32 v135, v198, 0, v135
    v_and_b32 v136, v198, v138
    v_bfi_b32 v137, v198, 0, v138
    v_and_b32 v138, v198, v139
    v_bfi_b32 v139, v198, 0, v139
    v_and_b32 v140, v198, v142
    v_bfi_b32 v141, v198, 0, v142
    v_and_b32 v142, v198, v143
    v_bfi_b32 v143, v198, 0, v143
    s_barrier
    ds_read_b128 v[144:147], v192 offset:0
    ds_read_b128 v[148:151], v192 offset:3840
    ds_read_b128 v[152:155], v192 offset:7680
    ds_read_b128 v[156:159], v192 offset:11520
    ds_read_b128 v[204:207], v193 offset:0
    ds_read_b128 v[160:163], v192 offset:64
    ds_read_b128 v[164:167], v192 offset:3904
    ds_read_b128 v[168:171], v192 offset:7744
    ds_read_b128 v[172:175], v192 offset:11584
    s_waitcnt lgkmcnt(7)
    v_smfmac_f32_16x16x64_bf16 v[0:3], v[84:87], v[144:151], v199
    ds_read_b128 v[216:219], v193 offset:64
    s_waitcnt lgkmcnt(6)
    v_smfmac_f32_16x16x64_bf16 v[0:3], v[88:91], v[152:159], v199
    ds_read_b128 v[176:179], v192 offset:128
    v_smfmac_f32_16x16x64_bf16 v[4:7], v[84:87], v[152:159], v199
    ds_read_b128 v[180:183], v192 offset:3968
    ds_read_b128 v[184:187], v192 offset:7808
    ds_read_b128 v[188:191], v192 offset:11648
    s_waitcnt lgkmcnt(7)
    v_smfmac_f32_16x16x64_bf16 v[16:19], v[104:107], v[160:167], v199
    ds_read_b128 v[64:67], v193 offset:128
    s_waitcnt lgkmcnt(6)
    v_smfmac_f32_16x16x64_bf16 v[16:19], v[108:111], v[168:175], v199
    v_smfmac_f32_16x16x64_bf16 v[20:23], v[104:107], v[168:175], v199
    s_waitcnt lgkmcnt(3)
    v_smfmac_f32_16x16x64_bf16 v[32:35], v[124:127], v[176:183], v199
    s_waitcnt lgkmcnt(1)
    v_smfmac_f32_16x16x64_bf16 v[32:35], v[128:131], v[184:191], v199
    v_smfmac_f32_16x16x64_bf16 v[36:39], v[124:127], v[184:191], v199
    v_add_u32 v240, s57, v240
    v_add_u32 v241, s57, v241
    v_add_u32 v242, s57, v242
    s_and_b32 s44, s3, 1
    s_lshl_b32 s43, s44, 5
    v_xor_b32 v56, s43, v56
    v_xor_b32 v60, 32, v56
    s_add_u32 s61, s60, 172032
    v_add_u32 v245, 12288, v52
    s_add_u32 s45, s59, 49152
    v_add_u32 v48, s45, v53
    v_xor_b32 v49, 8, v48
    v_xor_b32 v50, 16, v48
    v_xor_b32 v51, 24, v48
    s_mul_i32 s44, s3, 3840
    s_add_u32 s44, s44, 81792
    v_add_u32 v200, s44, v54
    v_xor_b32 v201, 16, v200
    v_add_u32 v246, s57, v55
    v_xor_b32 v247, 16, v246
    s_barrier
    ds_read_b128 v[144:147], v192 offset:15360
    ds_read_b128 v[148:151], v192 offset:19200
    ds_read_b128 v[152:155], v192 offset:23040
    ds_read_b128 v[156:159], v192 offset:26880
    ds_read_b128 v[208:211], v193 offset:15360
    ds_read_b128 v[160:163], v192 offset:15424
    ds_read_b128 v[164:167], v192 offset:19264
    ds_read_b128 v[168:171], v192 offset:23104
    ds_read_b128 v[172:175], v192 offset:26944
    s_waitcnt lgkmcnt(7)
    v_smfmac_f32_16x16x64_bf16 v[0:3], v[92:95], v[144:151], v199
    ds_read_b128 v[220:223], v193 offset:15424
    v_smfmac_f32_16x16x64_bf16 v[4:7], v[88:91], v[144:151], v199
    v_smfmac_f32_16x16x64_bf16 v[8:11], v[84:87], v[144:151], v199
    s_waitcnt lgkmcnt(6)
    v_smfmac_f32_16x16x64_bf16 v[4:7], v[92:95], v[152:159], v199
    ds_read_b128 v[176:179], v192 offset:15488
    v_smfmac_f32_16x16x64_bf16 v[8:11], v[88:91], v[152:159], v199
    ds_read_b128 v[180:183], v192 offset:19328
    v_smfmac_f32_16x16x64_bf16 v[12:15], v[84:87], v[152:159], v199
    s_waitcnt lgkmcnt(7)
    v_smfmac_f32_16x16x64_bf16 v[0:3], v[96:99], v[204:211], v199
    ds_read_b128 v[184:187], v192 offset:23168
    v_smfmac_f32_16x16x64_bf16 v[4:7], v[100:103], v[204:211], v199
    ds_read_b128 v[188:191], v192 offset:27008
    s_waitcnt lgkmcnt(7)
    v_smfmac_f32_16x16x64_bf16 v[16:19], v[112:115], v[160:167], v199
    ds_read_b128 v[68:71], v193 offset:15488
    v_smfmac_f32_16x16x64_bf16 v[20:23], v[108:111], v[160:167], v199
    v_smfmac_f32_16x16x64_bf16 v[24:27], v[104:107], v[160:167], v199
    v_cvt_pk_bf16_f32 v0, v0, v1
    v_cvt_pk_bf16_f32 v1, v2, v3
    v_cvt_pk_bf16_f32 v4, v4, v5
    v_cvt_pk_bf16_f32 v5, v6, v7
    ds_write_b64 v195, v[0:1] offset:0
    ds_write_b64 v195, v[4:5] offset:6144
    s_waitcnt lgkmcnt(8)
    v_smfmac_f32_16x16x64_bf16 v[20:23], v[112:115], v[168:175], v199
    v_smfmac_f32_16x16x64_bf16 v[24:27], v[108:111], v[168:175], v199
    v_smfmac_f32_16x16x64_bf16 v[28:31], v[104:107], v[168:175], v199
    s_waitcnt lgkmcnt(7)
    v_smfmac_f32_16x16x64_bf16 v[16:19], v[116:119], v[216:223], v199
    v_smfmac_f32_16x16x64_bf16 v[20:23], v[120:123], v[216:223], v199
    s_waitcnt lgkmcnt(5)
    v_smfmac_f32_16x16x64_bf16 v[32:35], v[132:135], v[176:183], v199
    v_smfmac_f32_16x16x64_bf16 v[36:39], v[128:131], v[176:183], v199
    v_smfmac_f32_16x16x64_bf16 v[40:43], v[124:127], v[176:183], v199
    s_nop 2
    v_cvt_pk_bf16_f32 v16, v16, v17
    v_cvt_pk_bf16_f32 v17, v18, v19
    v_cvt_pk_bf16_f32 v20, v20, v21
    v_cvt_pk_bf16_f32 v21, v22, v23
    ds_write_b64 v195, v[16:17] offset:64
    ds_write_b64 v195, v[20:21] offset:6208
    s_waitcnt lgkmcnt(5)
    v_smfmac_f32_16x16x64_bf16 v[36:39], v[132:135], v[184:191], v199
    v_smfmac_f32_16x16x64_bf16 v[40:43], v[128:131], v[184:191], v199
    v_smfmac_f32_16x16x64_bf16 v[44:47], v[124:127], v[184:191], v199
    s_waitcnt lgkmcnt(4)
    v_smfmac_f32_16x16x64_bf16 v[32:35], v[136:139], v[64:71], v199
    v_smfmac_f32_16x16x64_bf16 v[36:39], v[140:143], v[64:71], v199
    s_nop 6
    v_cvt_pk_bf16_f32 v32, v32, v33
    v_cvt_pk_bf16_f32 v33, v34, v35
    v_cvt_pk_bf16_f32 v36, v36, v37
    v_cvt_pk_bf16_f32 v37, v38, v39
    ds_write_b64 v195, v[32:33] offset:128
    ds_write_b64 v195, v[36:37] offset:6272
    s_waitcnt vmcnt(0)
    s_barrier
    s_setprio 3
    ds_read_b128 v[144:147], v192 offset:30720
    ds_read_b128 v[148:151], v192 offset:34560
    ds_read_b128 v[152:155], v192 offset:38400
    ds_read_b128 v[156:159], v192 offset:42240
    ds_read_b128 v[212:215], v193 offset:30720
    ds_read_b128 v[160:163], v192 offset:30784
    ds_read_b128 v[164:167], v192 offset:34624
    ds_read_b128 v[168:171], v192 offset:38464
    ds_read_b128 v[172:175], v192 offset:42304
    s_waitcnt lgkmcnt(7)
    v_smfmac_f32_16x16x64_bf16 v[8:11], v[92:95], v[144:151], v199
    ds_read_b128 v[224:227], v193 offset:30784
    v_smfmac_f32_16x16x64_bf16 v[12:15], v[88:91], v[144:151], v199
    s_waitcnt lgkmcnt(6)
    v_smfmac_f32_16x16x64_bf16 v[12:15], v[92:95], v[152:159], v199
    ds_read_b128 v[176:179], v192 offset:30848
    ds_read_b128 v[180:183], v192 offset:34688
    s_waitcnt lgkmcnt(7)
    v_smfmac_f32_16x16x64_bf16 v[8:11], v[96:99], v[208:215], v199
    ds_read_b128 v[184:187], v192 offset:38528
    v_smfmac_f32_16x16x64_bf16 v[12:15], v[100:103], v[208:215], v199
    ds_read_b128 v[188:191], v192 offset:42368
    s_waitcnt lgkmcnt(7)
    v_smfmac_f32_16x16x64_bf16 v[24:27], v[112:115], v[160:167], v199
    ds_read_b128 v[72:75], v193 offset:30848
    v_smfmac_f32_16x16x64_bf16 v[28:31], v[108:111], v[160:167], v199
    s_nop 0
    v_cvt_pk_bf16_f32 v8, v8, v9
    v_cvt_pk_bf16_f32 v9, v10, v11
    v_cvt_pk_bf16_f32 v12, v12, v13
    v_cvt_pk_bf16_f32 v13, v14, v15
    ds_write_b64 v195, v[8:9] offset:12288
    ds_write_b64 v195, v[12:13] offset:18432
    s_waitcnt lgkmcnt(8)
    v_smfmac_f32_16x16x64_bf16 v[28:31], v[112:115], v[168:175], v199
    s_waitcnt lgkmcnt(7)
    v_smfmac_f32_16x16x64_bf16 v[24:27], v[116:119], v[220:227], v199
    v_smfmac_f32_16x16x64_bf16 v[28:31], v[120:123], v[220:227], v199
    s_waitcnt lgkmcnt(5)
    v_smfmac_f32_16x16x64_bf16 v[40:43], v[132:135], v[176:183], v199
    v_smfmac_f32_16x16x64_bf16 v[44:47], v[128:131], v[176:183], v199
    s_nop 3
    v_cvt_pk_bf16_f32 v24, v24, v25
    v_cvt_pk_bf16_f32 v25, v26, v27
    v_cvt_pk_bf16_f32 v28, v28, v29
    v_cvt_pk_bf16_f32 v29, v30, v31
    ds_write_b64 v195, v[24:25] offset:12352
    ds_write_b64 v195, v[28:29] offset:18496
    s_waitcnt lgkmcnt(5)
    v_smfmac_f32_16x16x64_bf16 v[44:47], v[132:135], v[184:191], v199
    s_waitcnt lgkmcnt(4)
    v_smfmac_f32_16x16x64_bf16 v[40:43], v[136:139], v[68:75], v199
    v_smfmac_f32_16x16x64_bf16 v[44:47], v[140:143], v[68:75], v199
    s_nop 6
    v_cvt_pk_bf16_f32 v40, v40, v41
    v_cvt_pk_bf16_f32 v41, v42, v43
    v_cvt_pk_bf16_f32 v44, v44, v45
    v_cvt_pk_bf16_f32 v45, v46, v47
    ds_write_b64 v195, v[40:41] offset:12416
    ds_write_b64 v195, v[44:45] offset:18560
    s_waitcnt vmcnt(0)
    v_mov_b32 v254, 1
    ds_write_b32 v248, v254
L_poll0:
    ds_read_b32 v249, v243 offset:0
    s_waitcnt lgkmcnt(0)
    v_cmp_gt_u32 vcc, 1, v249
    s_cbranch_vccnz L_poll0
    ds_read_b64 v[168:169], v48 offset:0
    ds_read_b64 v[170:171], v49 offset:0
    ds_read_b64 v[172:173], v50 offset:0
    ds_read_b64 v[174:175], v51 offset:0
    ds_read_b64 v[176:177], v48 offset:64
    ds_read_b64 v[178:179], v49 offset:64
    ds_read_b64 v[180:181], v50 offset:64
    ds_read_b64 v[182:183], v51 offset:64
    ds_read_b64 v[184:185], v48 offset:128
    ds_read_b64 v[186:187], v49 offset:128
    ds_read_b64 v[188:189], v50 offset:128
    ds_read_b64 v[190:191], v51 offset:128
    s_setprio 1
    s_waitcnt lgkmcnt(0)
    v_mov_b32 v254, 0x3f803f80
    v_lshlrev_b32 v72, 16, v168
    v_and_b32 v73, 0xffff0000, v168
    v_lshlrev_b32 v74, 16, v169
    v_and_b32 v75, 0xffff0000, v169
    v_lshlrev_b32 v76, 16, v170
    v_and_b32 v77, 0xffff0000, v170
    v_lshlrev_b32 v78, 16, v171
    v_and_b32 v79, 0xffff0000, v171
    v_lshlrev_b32 v80, 16, v172
    v_and_b32 v81, 0xffff0000, v172
    v_lshlrev_b32 v82, 16, v173
    v_and_b32 v83, 0xffff0000, v173
    v_lshlrev_b32 v84, 16, v174
    v_and_b32 v85, 0xffff0000, v174
    v_lshlrev_b32 v86, 16, v175
    v_and_b32 v87, 0xffff0000, v175
    v_lshlrev_b32 v88, 16, v176
    v_and_b32 v89, 0xffff0000, v176
    v_lshlrev_b32 v90, 16, v177
    v_and_b32 v91, 0xffff0000, v177
    v_lshlrev_b32 v92, 16, v178
    v_and_b32 v93, 0xffff0000, v178
    v_lshlrev_b32 v94, 16, v179
    v_and_b32 v95, 0xffff0000, v179
    v_lshlrev_b32 v96, 16, v180
    v_and_b32 v97, 0xffff0000, v180
    v_lshlrev_b32 v98, 16, v181
    v_and_b32 v99, 0xffff0000, v181
    v_lshlrev_b32 v100, 16, v182
    v_and_b32 v101, 0xffff0000, v182
    v_lshlrev_b32 v102, 16, v183
    v_and_b32 v103, 0xffff0000, v183
    v_lshlrev_b32 v104, 16, v184
    v_and_b32 v105, 0xffff0000, v184
    v_lshlrev_b32 v106, 16, v185
    v_and_b32 v107, 0xffff0000, v185
    v_lshlrev_b32 v108, 16, v186
    v_and_b32 v109, 0xffff0000, v186
    v_lshlrev_b32 v110, 16, v187
    v_and_b32 v111, 0xffff0000, v187
    s_add_u32 m0, s59, 0
    s_add_u32 s43, s58, 0
    buffer_load_dwordx4 v56, s[28:31], s43 offen lds
    s_add_u32 m0, s59, 1024
    s_add_u32 s43, s58, 6144
    buffer_load_dwordx4 v60, s[28:31], s43 offen lds
    s_add_u32 m0, s59, 2048
    s_add_u32 s43, s58, 12288
    buffer_load_dwordx4 v56, s[28:31], s43 offen lds
    s_add_u32 m0, s59, 24576
    s_add_u32 s43, s58, 128
    buffer_load_dwordx4 v56, s[28:31], s43 offen lds
    s_add_u32 m0, s59, 25600
    s_add_u32 s43, s58, 6272
    buffer_load_dwordx4 v60, s[28:31], s43 offen lds
    s_add_u32 m0, s59, 26624
    s_add_u32 s43, s58, 12416
    buffer_load_dwordx4 v56, s[28:31], s43 offen lds
    v_dot2_f32_bf16 v251, v168, v254, 0
    v_dot2_f32_bf16 v253, v168, v168, 0
    v_dot2_f32_bf16 v251, v169, v254, v251
    v_dot2_f32_bf16 v253, v169, v169, v253
    v_dot2_f32_bf16 v251, v170, v254, v251
    v_dot2_f32_bf16 v253, v170, v170, v253
    v_dot2_f32_bf16 v251, v171, v254, v251
    v_dot2_f32_bf16 v253, v171, v171, v253
    v_dot2_f32_bf16 v251, v172, v254, v251
    v_dot2_f32_bf16 v253, v172, v172, v253
    v_dot2_f32_bf16 v251, v173, v254, v251
    v_dot2_f32_bf16 v253, v173, v173, v253
    v_dot2_f32_bf16 v251, v174, v254, v251
    v_dot2_f32_bf16 v253, v174, v174, v253
    v_dot2_f32_bf16 v251, v175, v254, v251
    v_dot2_f32_bf16 v253, v175, v175, v253
    v_dot2_f32_bf16 v251, v176, v254, v251
    v_dot2_f32_bf16 v253, v176, v176, v253
    v_dot2_f32_bf16 v251, v177, v254, v251
    v_dot2_f32_bf16 v253, v177, v177, v253
    v_dot2_f32_bf16 v251, v178, v254, v251
    v_dot2_f32_bf16 v253, v178, v178, v253
    v_dot2_f32_bf16 v251, v179, v254, v251
    v_dot2_f32_bf16 v253, v179, v179, v253
    v_dot2_f32_bf16 v251, v180, v254, v251
    v_dot2_f32_bf16 v253, v180, v180, v253
    v_dot2_f32_bf16 v251, v181, v254, v251
    v_dot2_f32_bf16 v253, v181, v181, v253
    v_dot2_f32_bf16 v251, v182, v254, v251
    v_dot2_f32_bf16 v253, v182, v182, v253
    v_dot2_f32_bf16 v251, v183, v254, v251
    v_dot2_f32_bf16 v253, v183, v183, v253
    v_dot2_f32_bf16 v251, v184, v254, v251
    v_dot2_f32_bf16 v253, v184, v184, v253
    v_dot2_f32_bf16 v251, v185, v254, v251
    v_dot2_f32_bf16 v253, v185, v185, v253
    v_dot2_f32_bf16 v251, v186, v254, v251
    v_dot2_f32_bf16 v253, v186, v186, v253
    v_dot2_f32_bf16 v251, v187, v254, v251
    v_dot2_f32_bf16 v253, v187, v187, v253
    v_dot2_f32_bf16 v251, v188, v254, v251
    v_dot2_f32_bf16 v253, v188, v188, v253
    v_dot2_f32_bf16 v251, v189, v254, v251
    v_dot2_f32_bf16 v253, v189, v189, v253
    v_dot2_f32_bf16 v251, v190, v254, v251
    v_dot2_f32_bf16 v253, v190, v190, v253
    v_dot2_f32_bf16 v251, v191, v254, v251
    v_dot2_f32_bf16 v253, v191, v191, v253
    v_lshlrev_b32 v112, 16, v188
    v_and_b32 v113, 0xffff0000, v188
    v_lshlrev_b32 v114, 16, v189
    v_permlane32_swap_b32 v251, v253
    v_add_f32 v251, v251, v253
    v_mul_f32 v251, 0x3c2aaaab, v251
    v_mov_b32 v253, v251
    v_and_b32 v115, 0xffff0000, v189
    v_lshlrev_b32 v116, 16, v190
    v_permlane32_swap_b32 v251, v253
    v_fma_f32 v253, -v251, v251, v253
    v_max_f32 v253, 0, v253
    v_add_f32 v253, 0x3727c5ac, v253
    v_rsq_f32 v253, v253
    v_and_b32 v117, 0xffff0000, v190
    v_mul_f32 v250, 0x3eeff558, v253
    v_mul_f32 v252, -v251, v250
    v_lshlrev_b32 v118, 16, v191
    v_and_b32 v119, 0xffff0000, v191
    ds_read_b128 v[204:207], v200 offset:0
    ds_read_b128 v[208:211], v201 offset:0
    ds_read_b128 v[212:215], v200 offset:64
    ds_read_b128 v[216:219], v201 offset:64
    ds_read_b128 v[220:223], v200 offset:128
    ds_read_b128 v[224:227], v201 offset:128
    s_waitcnt vmcnt(0)
    v_mov_b32 v254, 2
    ds_write_b32 v248, v254
    s_add_u32 m0, s59, 12288
    s_add_u32 s43, s59, 0
    buffer_load_dwordx4 v57, s[32:35], s43 offen offset:0 lds
    buffer_load_dwordx4 v58, s[32:35], s43 offen offset:1024 lds
    buffer_load_dwordx4 v59, s[32:35], s43 offen offset:2048 lds
    s_add_u32 m0, s59, 36864
    s_add_u32 s43, s59, 12288
    buffer_load_dwordx4 v57, s[32:35], s43 offen offset:0 lds
    buffer_load_dwordx4 v58, s[32:35], s43 offen offset:1024 lds
    buffer_load_dwordx4 v59, s[32:35], s43 offen offset:2048 lds
    ds_read_b32 v249, v243 offset:0
    v_pk_fma_f32 v[72:73], v[72:73], v[250:251], v[252:253] op_sel_hi:[1,0,0]
    v_pk_fma_f32 v[74:75], v[74:75], v[250:251], v[252:253] op_sel_hi:[1,0,0]
    v_pk_fma_f32 v[76:77], v[76:77], v[250:251], v[252:253] op_sel_hi:[1,0,0]
    v_pk_fma_f32 v[78:79], v[78:79], v[250:251], v[252:253] op_sel_hi:[1,0,0]
    v_pk_fma_f32 v[80:81], v[80:81], v[250:251], v[252:253] op_sel_hi:[1,0,0]
    v_pk_fma_f32 v[82:83], v[82:83], v[250:251], v[252:253] op_sel_hi:[1,0,0]
    v_pk_fma_f32 v[84:85], v[84:85], v[250:251], v[252:253] op_sel_hi:[1,0,0]
    v_pk_fma_f32 v[86:87], v[86:87], v[250:251], v[252:253] op_sel_hi:[1,0,0]
    v_pk_fma_f32 v[88:89], v[88:89], v[250:251], v[252:253] op_sel_hi:[1,0,0]
    v_pk_fma_f32 v[90:91], v[90:91], v[250:251], v[252:253] op_sel_hi:[1,0,0]
    v_pk_fma_f32 v[92:93], v[92:93], v[250:251], v[252:253] op_sel_hi:[1,0,0]
    v_pk_fma_f32 v[94:95], v[94:95], v[250:251], v[252:253] op_sel_hi:[1,0,0]
    v_pk_fma_f32 v[96:97], v[96:97], v[250:251], v[252:253] op_sel_hi:[1,0,0]
    v_pk_fma_f32 v[98:99], v[98:99], v[250:251], v[252:253] op_sel_hi:[1,0,0]
    v_pk_fma_f32 v[100:101], v[100:101], v[250:251], v[252:253] op_sel_hi:[1,0,0]
    v_pk_fma_f32 v[102:103], v[102:103], v[250:251], v[252:253] op_sel_hi:[1,0,0]
    v_pk_fma_f32 v[104:105], v[104:105], v[250:251], v[252:253] op_sel_hi:[1,0,0]
    v_pk_fma_f32 v[106:107], v[106:107], v[250:251], v[252:253] op_sel_hi:[1,0,0]
    v_pk_fma_f32 v[108:109], v[108:109], v[250:251], v[252:253] op_sel_hi:[1,0,0]
    v_pk_fma_f32 v[110:111], v[110:111], v[250:251], v[252:253] op_sel_hi:[1,0,0]
    v_pk_fma_f32 v[112:113], v[112:113], v[250:251], v[252:253] op_sel_hi:[1,0,0]
    v_pk_fma_f32 v[114:115], v[114:115], v[250:251], v[252:253] op_sel_hi:[1,0,0]
    v_pk_fma_f32 v[116:117], v[116:117], v[250:251], v[252:253] op_sel_hi:[1,0,0]
    v_pk_fma_f32 v[118:119], v[118:119], v[250:251], v[252:253] op_sel_hi:[1,0,0]
    s_waitcnt lgkmcnt(0)
    v_cmp_gt_u32 vcc, 2, v249
    s_cbranch_vccnz L_slow1
L_back1:
    ds_read_b64_tr_b16 v[144:145], v236 offset:0
    ds_read_b64_tr_b16 v[146:147], v236 offset:512
    ds_read_b64_tr_b16 v[148:149], v238 offset:1024
    ds_read_b64_tr_b16 v[150:151], v238 offset:1536
    ds_read_b64_tr_b16 v[152:153], v236 offset:4096
    ds_read_b64_tr_b16 v[154:155], v236 offset:4608
    ds_read_b64_tr_b16 v[156:157], v238 offset:5120
    ds_read_b64_tr_b16 v[158:159], v238 offset:5632
    ds_read_b64_tr_b16 v[160:161], v236 offset:8192
    ds_read_b64_tr_b16 v[162:163], v236 offset:8704
    ds_read_b64_tr_b16 v[164:165], v238 offset:9216
    ds_read_b64_tr_b16 v[166:167], v238 offset:9728
    v_cvt_pk_bf16_f32 v48, v72, v73
    v_cvt_pk_bf16_f32 v49, v74, v75
    v_cvt_pk_bf16_f32 v50, v76, v77
    v_cvt_pk_bf16_f32 v51, v78, v79
    v_cvt_pk_bf16_f32 v52, v80, v81
    v_cvt_pk_bf16_f32 v53, v82, v83
    v_cvt_pk_bf16_f32 v54, v84, v85
    v_cvt_pk_bf16_f32 v55, v86, v87
    v_cvt_pk_bf16_f32 v56, v88, v89
    v_cvt_pk_bf16_f32 v57, v90, v91
    v_cvt_pk_bf16_f32 v58, v92, v93
    v_cvt_pk_bf16_f32 v59, v94, v95
    v_cvt_pk_bf16_f32 v60, v96, v97
    v_cvt_pk_bf16_f32 v61, v98, v99
    v_cvt_pk_bf16_f32 v62, v100, v101
    v_cvt_pk_bf16_f32 v63, v102, v103
    v_cvt_pk_bf16_f32 v64, v104, v105
    v_cvt_pk_bf16_f32 v65, v106, v107
    v_cvt_pk_bf16_f32 v66, v108, v109
    v_cvt_pk_bf16_f32 v67, v110, v111
    v_cvt_pk_bf16_f32 v68, v112, v113
    v_cvt_pk_bf16_f32 v69, v114, v115
    v_cvt_pk_bf16_f32 v70, v116, v117
    v_cvt_pk_bf16_f32 v71, v118, v119
    s_waitcnt lgkmcnt(0)
    v_mfma_f32_32x32x16_bf16 v[72:87], v[144:147], v[48:51], 0
    v_mfma_f32_32x32x16_bf16 v[72:87], v[148:151], v[52:55], v[72:87]
    v_mfma_f32_32x32x16_bf16 v[72:87], v[152:155], v[56:59], v[72:87]
    v_mfma_f32_32x32x16_bf16 v[72:87], v[156:159], v[60:63], v[72:87]
    v_mfma_f32_32x32x16_bf16 v[72:87], v[160:163], v[64:67], v[72:87]
    v_mfma_f32_32x32x16_bf16 v[72:87], v[164:167], v[68:71], v[72:87]
    ds_read_b64_tr_b16 v[144:145], v237 offset:0
    ds_read_b64_tr_b16 v[146:147], v237 offset:512
    ds_read_b64_tr_b16 v[148:149], v239 offset:1024
    ds_read_b64_tr_b16 v[150:151], v239 offset:1536
    ds_read_b64_tr_b16 v[152:153], v237 offset:4096
    ds_read_b64_tr_b16 v[154:155], v237 offset:4608
    ds_read_b64_tr_b16 v[156:157], v239 offset:5120
    ds_read_b64_tr_b16 v[158:159], v239 offset:5632
    ds_read_b64_tr_b16 v[160:161], v237 offset:8192
    ds_read_b64_tr_b16 v[162:163], v237 offset:8704
    ds_read_b64_tr_b16 v[164:165], v239 offset:9216
    ds_read_b64_tr_b16 v[166:167], v239 offset:9728
    s_waitcnt vmcnt(0)
    v_mov_b32 v254, 3
    ds_write_b32 v248, v254
    s_setprio 0
    v_pk_fma_f32 v[104:105], v[72:73], v[72:73], s[50:51] neg_lo:[1,0,0] neg_hi:[1,0,0]
    v_pk_fma_f32 v[106:107], v[74:75], v[74:75], s[50:51] neg_lo:[1,0,0] neg_hi:[1,0,0]
    v_pk_fma_f32 v[108:109], v[76:77], v[76:77], s[50:51] neg_lo:[1,0,0] neg_hi:[1,0,0]
    v_pk_fma_f32 v[110:111], v[78:79], v[78:79], s[50:51] neg_lo:[1,0,0] neg_hi:[1,0,0]
    v_pk_fma_f32 v[112:113], v[80:81], v[80:81], s[50:51] neg_lo:[1,0,0] neg_hi:[1,0,0]
    v_pk_fma_f32 v[114:115], v[82:83], v[82:83], s[50:51] neg_lo:[1,0,0] neg_hi:[1,0,0]
    v_pk_fma_f32 v[116:117], v[84:85], v[84:85], s[50:51] neg_lo:[1,0,0] neg_hi:[1,0,0]
    v_pk_fma_f32 v[118:119], v[86:87], v[86:87], s[50:51] neg_lo:[1,0,0] neg_hi:[1,0,0]
    v_pk_mul_f32 v[104:105], v[72:73], v[104:105]
    v_pk_mul_f32 v[106:107], v[74:75], v[106:107]
    v_pk_mul_f32 v[108:109], v[76:77], v[108:109]
    v_pk_mul_f32 v[110:111], v[78:79], v[110:111]
    v_pk_mul_f32 v[112:113], v[80:81], v[112:113]
    v_pk_mul_f32 v[114:115], v[82:83], v[114:115]
    v_pk_mul_f32 v[116:117], v[84:85], v[116:117]
    v_pk_mul_f32 v[118:119], v[86:87], v[118:119]
    s_waitcnt lgkmcnt(0)
    v_mfma_f32_32x32x16_bf16 v[88:103], v[144:147], v[48:51], 0
    v_exp_f32 v104, v104
    v_exp_f32 v105, v105
    v_exp_f32 v106, v106
    v_mfma_f32_32x32x16_bf16 v[88:103], v[148:151], v[52:55], v[88:103]
    v_exp_f32 v107, v107
    v_exp_f32 v108, v108
    v_exp_f32 v109, v109
    v_mfma_f32_32x32x16_bf16 v[88:103], v[152:155], v[56:59], v[88:103]
    v_exp_f32 v110, v110
    v_exp_f32 v111, v111
    v_exp_f32 v112, v112
    v_mfma_f32_32x32x16_bf16 v[88:103], v[156:159], v[60:63], v[88:103]
    v_exp_f32 v113, v113
    v_exp_f32 v114, v114
    v_exp_f32 v115, v115
    v_mfma_f32_32x32x16_bf16 v[88:103], v[160:163], v[64:67], v[88:103]
    v_exp_f32 v116, v116
    v_exp_f32 v117, v117
    v_exp_f32 v118, v118
    v_mfma_f32_32x32x16_bf16 v[88:103], v[164:167], v[68:71], v[88:103]
    v_exp_f32 v119, v119
    s_setprio 0
    ds_read_b64_tr_b16 v[144:145], v236 offset:24576
    ds_read_b64_tr_b16 v[146:147], v236 offset:25088
    ds_read_b64_tr_b16 v[148:149], v238 offset:25600
    ds_read_b64_tr_b16 v[150:151], v238 offset:26112
    ds_read_b64_tr_b16 v[152:153], v236 offset:28672
    ds_read_b64_tr_b16 v[154:155], v236 offset:29184
    ds_read_b64_tr_b16 v[156:157], v238 offset:29696
    ds_read_b64_tr_b16 v[158:159], v238 offset:30208
    ds_read_b64_tr_b16 v[160:161], v236 offset:32768
    ds_read_b64_tr_b16 v[162:163], v236 offset:33280
    ds_read_b64_tr_b16 v[164:165], v238 offset:33792
    ds_read_b64_tr_b16 v[166:167], v238 offset:34304
    ds_read_b32 v249, v243 offset:0
    s_setprio 0
    v_pk_fma_f32 v[104:105], v[104:105], s[48:49], s[48:49]
    v_pk_fma_f32 v[106:107], v[106:107], s[48:49], s[48:49]
    v_pk_fma_f32 v[108:109], v[108:109], s[48:49], s[48:49]
    v_pk_fma_f32 v[110:111], v[110:111], s[48:49], s[48:49]
    v_pk_fma_f32 v[112:113], v[112:113], s[48:49], s[48:49]
    v_pk_fma_f32 v[114:115], v[114:115], s[48:49], s[48:49]
    v_pk_fma_f32 v[116:117], v[116:117], s[48:49], s[48:49]
    v_pk_fma_f32 v[118:119], v[118:119], s[48:49], s[48:49]
    v_mfma_f32_32x32x16_bf16 v[0:15], v[228:231], v[204:207], 0
    v_rcp_f32 v104, v104
    v_rcp_f32 v105, v105
    v_rcp_f32 v106, v106
    v_mfma_f32_32x32x16_bf16 v[16:31], v[228:231], v[212:215], 0
    v_rcp_f32 v107, v107
    v_rcp_f32 v108, v108
    v_rcp_f32 v109, v109
    v_mfma_f32_32x32x16_bf16 v[32:47], v[228:231], v[220:223], 0
    v_rcp_f32 v110, v110
    v_rcp_f32 v111, v111
    v_rcp_f32 v112, v112
    v_mfma_f32_32x32x16_bf16 v[0:15], v[232:235], v[208:211], v[0:15]
    v_rcp_f32 v113, v113
    v_rcp_f32 v114, v114
    v_rcp_f32 v115, v115
    v_mfma_f32_32x32x16_bf16 v[16:31], v[232:235], v[216:219], v[16:31]
    v_rcp_f32 v116, v116
    v_rcp_f32 v117, v117
    v_mfma_f32_32x32x16_bf16 v[32:47], v[232:235], v[224:227], v[32:47]
    s_waitcnt lgkmcnt(0)
    v_rcp_f32 v118, v118
    v_rcp_f32 v119, v119
    v_cmp_gt_u32 vcc, 3, v249
    s_cbranch_vccnz L_slow2
L_back2:
    s_setprio 0
    ds_read_b64_tr_b16 v[168:169], v245 offset:0
    ds_read_b64_tr_b16 v[170:171], v245 offset:1536
    ds_read_b64_tr_b16 v[172:173], v245 offset:64
    ds_read_b64_tr_b16 v[174:175], v245 offset:1600
    ds_read_b64_tr_b16 v[176:177], v245 offset:128
    ds_read_b64_tr_b16 v[178:179], v245 offset:1664
    ds_read_b64_tr_b16 v[180:181], v245 offset:3072
    ds_read_b64_tr_b16 v[182:183], v245 offset:4608
    ds_read_b64_tr_b16 v[184:185], v245 offset:3136
    ds_read_b64_tr_b16 v[186:187], v245 offset:4672
    ds_read_b64_tr_b16 v[188:189], v245 offset:3200
    ds_read_b64_tr_b16 v[190:191], v245 offset:4736
    v_pk_mul_f32 v[104:105], v[72:73], v[104:105]
    v_pk_mul_f32 v[106:107], v[74:75], v[106:107]
    v_pk_mul_f32 v[108:109], v[76:77], v[108:109]
    v_pk_mul_f32 v[110:111], v[78:79], v[110:111]
    v_pk_mul_f32 v[112:113], v[80:81], v[112:113]
    v_pk_mul_f32 v[114:115], v[82:83], v[114:115]
    v_pk_mul_f32 v[116:117], v[84:85], v[116:117]
    v_pk_mul_f32 v[118:119], v[86:87], v[118:119]
    v_pk_fma_f32 v[120:121], v[88:89], v[88:89], s[50:51] neg_lo:[1,0,0] neg_hi:[1,0,0]
    v_pk_fma_f32 v[122:123], v[90:91], v[90:91], s[50:51] neg_lo:[1,0,0] neg_hi:[1,0,0]
    v_pk_fma_f32 v[124:125], v[92:93], v[92:93], s[50:51] neg_lo:[1,0,0] neg_hi:[1,0,0]
    v_pk_fma_f32 v[126:127], v[94:95], v[94:95], s[50:51] neg_lo:[1,0,0] neg_hi:[1,0,0]
    v_pk_fma_f32 v[128:129], v[96:97], v[96:97], s[50:51] neg_lo:[1,0,0] neg_hi:[1,0,0]
    v_pk_fma_f32 v[130:131], v[98:99], v[98:99], s[50:51] neg_lo:[1,0,0] neg_hi:[1,0,0]
    v_pk_fma_f32 v[132:133], v[100:101], v[100:101], s[50:51] neg_lo:[1,0,0] neg_hi:[1,0,0]
    v_pk_fma_f32 v[134:135], v[102:103], v[102:103], s[50:51] neg_lo:[1,0,0] neg_hi:[1,0,0]
    v_pk_mul_f32 v[120:121], v[88:89], v[120:121]
    v_pk_mul_f32 v[122:123], v[90:91], v[122:123]
    v_pk_mul_f32 v[124:125], v[92:93], v[124:125]
    v_pk_mul_f32 v[126:127], v[94:95], v[126:127]
    v_pk_mul_f32 v[128:129], v[96:97], v[128:129]
    v_pk_mul_f32 v[130:131], v[98:99], v[130:131]
    v_pk_mul_f32 v[132:133], v[100:101], v[132:133]
    v_pk_mul_f32 v[134:135], v[102:103], v[134:135]
    v_mfma_f32_32x32x16_bf16 v[72:87], v[144:147], v[48:51], 0
    v_cvt_pk_bf16_f32 v136, v104, v105
    v_cvt_pk_bf16_f32 v137, v106, v107
    v_cvt_pk_bf16_f32 v138, v108, v109
    v_cvt_pk_bf16_f32 v139, v110, v111
    v_exp_f32 v120, v120
    v_mfma_f32_32x32x16_bf16 v[72:87], v[148:151], v[52:55], v[72:87]
    v_cvt_pk_bf16_f32 v140, v112, v113
    v_cvt_pk_bf16_f32 v141, v114, v115
    v_cvt_pk_bf16_f32 v142, v116, v117
    v_cvt_pk_bf16_f32 v143, v118, v119
    v_exp_f32 v121, v121
    v_mfma_f32_32x32x16_bf16 v[72:87], v[152:155], v[56:59], v[72:87]
    v_exp_f32 v122, v122
    v_exp_f32 v123, v123
    v_exp_f32 v124, v124
    v_mfma_f32_32x32x16_bf16 v[72:87], v[156:159], v[60:63], v[72:87]
    v_exp_f32 v125, v125
    v_exp_f32 v126, v126
    v_exp_f32 v127, v127
    v_mfma_f32_32x32x16_bf16 v[72:87], v[160:163], v[64:67], v[72:87]
    v_exp_f32 v128, v128
    v_exp_f32 v129, v129
    v_exp_f32 v130, v130
    v_mfma_f32_32x32x16_bf16 v[72:87], v[164:167], v[68:71], v[72:87]
    s_waitcnt lgkmcnt(0)
    v_exp_f32 v131, v131
    v_exp_f32 v132, v132
    v_exp_f32 v133, v133
    v_mfma_f32_32x32x16_bf16 v[0:15], v[168:171], v[136:139], v[0:15]
    v_exp_f32 v134, v134
    v_exp_f32 v135, v135
    ds_read_b64_tr_b16 v[144:145], v237 offset:24576
    ds_read_b64_tr_b16 v[146:147], v237 offset:25088
    ds_read_b64_tr_b16 v[148:149], v239 offset:25600
    ds_read_b64_tr_b16 v[150:151], v239 offset:26112
    ds_read_b64_tr_b16 v[152:153], v237 offset:28672
    ds_read_b64_tr_b16 v[154:155], v237 offset:29184
    ds_read_b64_tr_b16 v[156:157], v239 offset:29696
    ds_read_b64_tr_b16 v[158:159], v239 offset:30208
    ds_read_b64_tr_b16 v[160:161], v237 offset:32768
    ds_read_b64_tr_b16 v[162:163], v237 offset:33280
    ds_read_b64_tr_b16 v[164:165], v239 offset:33792
    ds_read_b64_tr_b16 v[166:167], v239 offset:34304
    v_pk_fma_f32 v[120:121], v[120:121], s[48:49], s[48:49]
    v_pk_fma_f32 v[122:123], v[122:123], s[48:49], s[48:49]
    v_pk_fma_f32 v[124:125], v[124:125], s[48:49], s[48:49]
    v_pk_fma_f32 v[126:127], v[126:127], s[48:49], s[48:49]
    v_pk_fma_f32 v[128:129], v[128:129], s[48:49], s[48:49]
    v_pk_fma_f32 v[130:131], v[130:131], s[48:49], s[48:49]
    v_pk_fma_f32 v[132:133], v[132:133], s[48:49], s[48:49]
    v_pk_fma_f32 v[134:135], v[134:135], s[48:49], s[48:49]
    v_mfma_f32_32x32x16_bf16 v[16:31], v[172:175], v[136:139], v[16:31]
    v_rcp_f32 v120, v120
    v_rcp_f32 v121, v121
    v_rcp_f32 v122, v122
    v_mfma_f32_32x32x16_bf16 v[32:47], v[176:179], v[136:139], v[32:47]
    v_rcp_f32 v123, v123
    v_rcp_f32 v124, v124
    v_rcp_f32 v125, v125
    v_mfma_f32_32x32x16_bf16 v[0:15], v[180:183], v[140:143], v[0:15]
    v_rcp_f32 v126, v126
    v_rcp_f32 v127, v127
    v_rcp_f32 v128, v128
    v_mfma_f32_32x32x16_bf16 v[16:31], v[184:187], v[140:143], v[16:31]
    v_rcp_f32 v129, v129
    v_rcp_f32 v130, v130
    v_rcp_f32 v131, v131
    v_mfma_f32_32x32x16_bf16 v[32:47], v[188:191], v[140:143], v[32:47]
    s_waitcnt lgkmcnt(0)
    v_rcp_f32 v132, v132
    v_rcp_f32 v133, v133
    v_rcp_f32 v134, v134
    v_rcp_f32 v135, v135
    ds_read_b64_tr_b16 v[168:169], v245 offset:6144
    ds_read_b64_tr_b16 v[170:171], v245 offset:7680
    ds_read_b64_tr_b16 v[172:173], v245 offset:6208
    ds_read_b64_tr_b16 v[174:175], v245 offset:7744
    ds_read_b64_tr_b16 v[176:177], v245 offset:6272
    ds_read_b64_tr_b16 v[178:179], v245 offset:7808
    ds_read_b64_tr_b16 v[180:181], v245 offset:9216
    ds_read_b64_tr_b16 v[182:183], v245 offset:10752
    ds_read_b64_tr_b16 v[184:185], v245 offset:9280
    ds_read_b64_tr_b16 v[186:187], v245 offset:10816
    ds_read_b64_tr_b16 v[188:189], v245 offset:9344
    ds_read_b64_tr_b16 v[190:191], v245 offset:10880
    ds_read_b32 v249, v243 offset:16
    v_pk_mul_f32 v[120:121], v[88:89], v[120:121]
    v_pk_mul_f32 v[122:123], v[90:91], v[122:123]
    v_pk_mul_f32 v[124:125], v[92:93], v[124:125]
    v_pk_mul_f32 v[126:127], v[94:95], v[126:127]
    v_pk_mul_f32 v[128:129], v[96:97], v[128:129]
    v_pk_mul_f32 v[130:131], v[98:99], v[130:131]
    v_pk_mul_f32 v[132:133], v[100:101], v[132:133]
    v_pk_mul_f32 v[134:135], v[102:103], v[134:135]
    v_pk_fma_f32 v[104:105], v[72:73], v[72:73], s[50:51] neg_lo:[1,0,0] neg_hi:[1,0,0]
    v_pk_fma_f32 v[106:107], v[74:75], v[74:75], s[50:51] neg_lo:[1,0,0] neg_hi:[1,0,0]
    v_pk_fma_f32 v[108:109], v[76:77], v[76:77], s[50:51] neg_lo:[1,0,0] neg_hi:[1,0,0]
    v_pk_fma_f32 v[110:111], v[78:79], v[78:79], s[50:51] neg_lo:[1,0,0] neg_hi:[1,0,0]
    v_pk_fma_f32 v[112:113], v[80:81], v[80:81], s[50:51] neg_lo:[1,0,0] neg_hi:[1,0,0]
    v_pk_fma_f32 v[114:115], v[82:83], v[82:83], s[50:51] neg_lo:[1,0,0] neg_hi:[1,0,0]
    v_pk_fma_f32 v[116:117], v[84:85], v[84:85], s[50:51] neg_lo:[1,0,0] neg_hi:[1,0,0]
    v_pk_fma_f32 v[118:119], v[86:87], v[86:87], s[50:51] neg_lo:[1,0,0] neg_hi:[1,0,0]
    v_pk_mul_f32 v[104:105], v[72:73], v[104:105]
    v_pk_mul_f32 v[106:107], v[74:75], v[106:107]
    v_pk_mul_f32 v[108:109], v[76:77], v[108:109]
    v_pk_mul_f32 v[110:111], v[78:79], v[110:111]
    v_pk_mul_f32 v[112:113], v[80:81], v[112:113]
    v_pk_mul_f32 v[114:115], v[82:83], v[114:115]
    v_pk_mul_f32 v[116:117], v[84:85], v[116:117]
    v_pk_mul_f32 v[118:119], v[86:87], v[118:119]
    v_mfma_f32_32x32x16_bf16 v[88:103], v[144:147], v[48:51], 0
    v_cvt_pk_bf16_f32 v136, v120, v121
    v_cvt_pk_bf16_f32 v137, v122, v123
    v_cvt_pk_bf16_f32 v138, v124, v125
    v_cvt_pk_bf16_f32 v139, v126, v127
    v_exp_f32 v104, v104
    v_mfma_f32_32x32x16_bf16 v[88:103], v[148:151], v[52:55], v[88:103]
    v_cvt_pk_bf16_f32 v140, v128, v129
    v_cvt_pk_bf16_f32 v141, v130, v131
    v_cvt_pk_bf16_f32 v142, v132, v133
    v_cvt_pk_bf16_f32 v143, v134, v135
    v_exp_f32 v105, v105
    v_mfma_f32_32x32x16_bf16 v[88:103], v[152:155], v[56:59], v[88:103]
    v_exp_f32 v106, v106
    v_exp_f32 v107, v107
    v_exp_f32 v108, v108
    v_mfma_f32_32x32x16_bf16 v[88:103], v[156:159], v[60:63], v[88:103]
    v_exp_f32 v109, v109
    v_exp_f32 v110, v110
    v_exp_f32 v111, v111
    v_mfma_f32_32x32x16_bf16 v[88:103], v[160:163], v[64:67], v[88:103]
    v_exp_f32 v112, v112
    v_exp_f32 v113, v113
    v_exp_f32 v114, v114
    v_mfma_f32_32x32x16_bf16 v[88:103], v[164:167], v[68:71], v[88:103]
    s_waitcnt lgkmcnt(0)
    v_exp_f32 v115, v115
    v_exp_f32 v116, v116
    v_exp_f32 v117, v117
    v_mfma_f32_32x32x16_bf16 v[0:15], v[168:171], v[136:139], v[0:15]
    v_exp_f32 v118, v118
    v_exp_f32 v119, v119
    v_cmp_gt_u32 vcc, 6, v249
    s_cbranch_vccnz L_slow3
L_back3:
    ds_read_b64_tr_b16 v[144:145], v236 offset:49152
    ds_read_b64_tr_b16 v[146:147], v236 offset:49664
    ds_read_b64_tr_b16 v[148:149], v238 offset:50176
    ds_read_b64_tr_b16 v[150:151], v238 offset:50688
    ds_read_b64_tr_b16 v[152:153], v236 offset:53248
    ds_read_b64_tr_b16 v[154:155], v236 offset:53760
    ds_read_b64_tr_b16 v[156:157], v238 offset:54272
    ds_read_b64_tr_b16 v[158:159], v238 offset:54784
    ds_read_b64_tr_b16 v[160:161], v236 offset:57344
    ds_read_b64_tr_b16 v[162:163], v236 offset:57856
    ds_read_b64_tr_b16 v[164:165], v238 offset:58368
    ds_read_b64_tr_b16 v[166:167], v238 offset:58880
    v_pk_fma_f32 v[104:105], v[104:105], s[48:49], s[48:49]
    v_pk_fma_f32 v[106:107], v[106:107], s[48:49], s[48:49]
    v_pk_fma_f32 v[108:109], v[108:109], s[48:49], s[48:49]
    v_pk_fma_f32 v[110:111], v[110:111], s[48:49], s[48:49]
    v_pk_fma_f32 v[112:113], v[112:113], s[48:49], s[48:49]
    v_pk_fma_f32 v[114:115], v[114:115], s[48:49], s[48:49]
    v_pk_fma_f32 v[116:117], v[116:117], s[48:49], s[48:49]
    v_pk_fma_f32 v[118:119], v[118:119], s[48:49], s[48:49]
    v_mfma_f32_32x32x16_bf16 v[16:31], v[172:175], v[136:139], v[16:31]
    v_rcp_f32 v104, v104
    v_rcp_f32 v105, v105
    v_rcp_f32 v106, v106
    v_mfma_f32_32x32x16_bf16 v[32:47], v[176:179], v[136:139], v[32:47]
    v_rcp_f32 v107, v107
    v_rcp_f32 v108, v108
    v_rcp_f32 v109, v109
    v_mfma_f32_32x32x16_bf16 v[0:15], v[180:183], v[140:143], v[0:15]
    v_rcp_f32 v110, v110
    v_rcp_f32 v111, v111
    v_rcp_f32 v112, v112
    v_mfma_f32_32x32x16_bf16 v[16:31], v[184:187], v[140:143], v[16:31]
    v_rcp_f32 v113, v113
    v_rcp_f32 v114, v114
    v_rcp_f32 v115, v115
    v_mfma_f32_32x32x16_bf16 v[32:47], v[188:191], v[140:143], v[32:47]
    s_waitcnt lgkmcnt(0)
    v_rcp_f32 v116, v116
    v_rcp_f32 v117, v117
    v_rcp_f32 v118, v118
    v_rcp_f32 v119, v119
    ds_read_b64_tr_b16 v[168:169], v245 offset:24576
    ds_read_b64_tr_b16 v[170:171], v245 offset:26112
    ds_read_b64_tr_b16 v[172:173], v245 offset:24640
    ds_read_b64_tr_b16 v[174:175], v245 offset:26176
    ds_read_b64_tr_b16 v[176:177], v245 offset:24704
    ds_read_b64_tr_b16 v[178:179], v245 offset:26240
    ds_read_b64_tr_b16 v[180:181], v245 offset:27648
    ds_read_b64_tr_b16 v[182:183], v245 offset:29184
    ds_read_b64_tr_b16 v[184:185], v245 offset:27712
    ds_read_b64_tr_b16 v[186:187], v245 offset:29248
    ds_read_b64_tr_b16 v[188:189], v245 offset:27776
    ds_read_b64_tr_b16 v[190:191], v245 offset:29312
    v_pk_mul_f32 v[104:105], v[72:73], v[104:105]
    v_pk_mul_f32 v[106:107], v[74:75], v[106:107]
    v_pk_mul_f32 v[108:109], v[76:77], v[108:109]
    v_pk_mul_f32 v[110:111], v[78:79], v[110:111]
    v_pk_mul_f32 v[112:113], v[80:81], v[112:113]
    v_pk_mul_f32 v[114:115], v[82:83], v[114:115]
    v_pk_mul_f32 v[116:117], v[84:85], v[116:117]
    v_pk_mul_f32 v[118:119], v[86:87], v[118:119]
    v_pk_fma_f32 v[120:121], v[88:89], v[88:89], s[50:51] neg_lo:[1,0,0] neg_hi:[1,0,0]
    v_pk_fma_f32 v[122:123], v[90:91], v[90:91], s[50:51] neg_lo:[1,0,0] neg_hi:[1,0,0]
    v_pk_fma_f32 v[124:125], v[92:93], v[92:93], s[50:51] neg_lo:[1,0,0] neg_hi:[1,0,0]
    v_pk_fma_f32 v[126:127], v[94:95], v[94:95], s[50:51] neg_lo:[1,0,0] neg_hi:[1,0,0]
    v_pk_fma_f32 v[128:129], v[96:97], v[96:97], s[50:51] neg_lo:[1,0,0] neg_hi:[1,0,0]
    v_pk_fma_f32 v[130:131], v[98:99], v[98:99], s[50:51] neg_lo:[1,0,0] neg_hi:[1,0,0]
    v_pk_fma_f32 v[132:133], v[100:101], v[100:101], s[50:51] neg_lo:[1,0,0] neg_hi:[1,0,0]
    v_pk_fma_f32 v[134:135], v[102:103], v[102:103], s[50:51] neg_lo:[1,0,0] neg_hi:[1,0,0]
    v_pk_mul_f32 v[120:121], v[88:89], v[120:121]
    v_pk_mul_f32 v[122:123], v[90:91], v[122:123]
    v_pk_mul_f32 v[124:125], v[92:93], v[124:125]
    v_pk_mul_f32 v[126:127], v[94:95], v[126:127]
    v_pk_mul_f32 v[128:129], v[96:97], v[128:129]
    v_pk_mul_f32 v[130:131], v[98:99], v[130:131]
    v_pk_mul_f32 v[132:133], v[100:101], v[132:133]
    v_pk_mul_f32 v[134:135], v[102:103], v[134:135]
    v_mfma_f32_32x32x16_bf16 v[72:87], v[144:147], v[48:51], 0
    v_cvt_pk_bf16_f32 v136, v104, v105
    v_cvt_pk_bf16_f32 v137, v106, v107
    v_cvt_pk_bf16_f32 v138, v108, v109
    v_cvt_pk_bf16_f32 v139, v110, v111
    v_exp_f32 v120, v120
    v_mfma_f32_32x32x16_bf16 v[72:87], v[148:151], v[52:55], v[72:87]
    v_cvt_pk_bf16_f32 v140, v112, v113
    v_cvt_pk_bf16_f32 v141, v114, v115
    v_cvt_pk_bf16_f32 v142, v116, v117
    v_cvt_pk_bf16_f32 v143, v118, v119
    v_exp_f32 v121, v121
    v_mfma_f32_32x32x16_bf16 v[72:87], v[152:155], v[56:59], v[72:87]
    v_exp_f32 v122, v122
    v_exp_f32 v123, v123
    v_exp_f32 v124, v124
    v_mfma_f32_32x32x16_bf16 v[72:87], v[156:159], v[60:63], v[72:87]
    v_exp_f32 v125, v125
    v_exp_f32 v126, v126
    v_exp_f32 v127, v127
    v_mfma_f32_32x32x16_bf16 v[72:87], v[160:163], v[64:67], v[72:87]
    v_exp_f32 v128, v128
    v_exp_f32 v129, v129
    v_exp_f32 v130, v130
    v_mfma_f32_32x32x16_bf16 v[72:87], v[164:167], v[68:71], v[72:87]
    s_waitcnt lgkmcnt(0)
    v_exp_f32 v131, v131
    v_exp_f32 v132, v132
    v_exp_f32 v133, v133
    v_mfma_f32_32x32x16_bf16 v[0:15], v[168:171], v[136:139], v[0:15]
    v_exp_f32 v134, v134
    v_exp_f32 v135, v135
    ds_read_b64_tr_b16 v[144:145], v237 offset:49152
    ds_read_b64_tr_b16 v[146:147], v237 offset:49664
    ds_read_b64_tr_b16 v[148:149], v239 offset:50176
    ds_read_b64_tr_b16 v[150:151], v239 offset:50688
    ds_read_b64_tr_b16 v[152:153], v237 offset:53248
    ds_read_b64_tr_b16 v[154:155], v237 offset:53760
    ds_read_b64_tr_b16 v[156:157], v239 offset:54272
    ds_read_b64_tr_b16 v[158:159], v239 offset:54784
    ds_read_b64_tr_b16 v[160:161], v237 offset:57344
    ds_read_b64_tr_b16 v[162:163], v237 offset:57856
    ds_read_b64_tr_b16 v[164:165], v239 offset:58368
    ds_read_b64_tr_b16 v[166:167], v239 offset:58880
    v_pk_fma_f32 v[120:121], v[120:121], s[48:49], s[48:49]
    v_pk_fma_f32 v[122:123], v[122:123], s[48:49], s[48:49]
    v_pk_fma_f32 v[124:125], v[124:125], s[48:49], s[48:49]
    v_pk_fma_f32 v[126:127], v[126:127], s[48:49], s[48:49]
    v_pk_fma_f32 v[128:129], v[128:129], s[48:49], s[48:49]
    v_pk_fma_f32 v[130:131], v[130:131], s[48:49], s[48:49]
    v_pk_fma_f32 v[132:133], v[132:133], s[48:49], s[48:49]
    v_pk_fma_f32 v[134:135], v[134:135], s[48:49], s[48:49]
    v_mfma_f32_32x32x16_bf16 v[16:31], v[172:175], v[136:139], v[16:31]
    v_rcp_f32 v120, v120
    v_rcp_f32 v121, v121
    v_rcp_f32 v122, v122
    v_mfma_f32_32x32x16_bf16 v[32:47], v[176:179], v[136:139], v[32:47]
    v_rcp_f32 v123, v123
    v_rcp_f32 v124, v124
    v_rcp_f32 v125, v125
    v_mfma_f32_32x32x16_bf16 v[0:15], v[180:183], v[140:143], v[0:15]
    v_rcp_f32 v126, v126
    v_rcp_f32 v127, v127
    v_rcp_f32 v128, v128
    v_mfma_f32_32x32x16_bf16 v[16:31], v[184:187], v[140:143], v[16:31]
    v_rcp_f32 v129, v129
    v_rcp_f32 v130, v130
    v_rcp_f32 v131, v131
    v_mfma_f32_32x32x16_bf16 v[32:47], v[188:191], v[140:143], v[32:47]
    s_waitcnt lgkmcnt(0)
    v_rcp_f32 v132, v132
    v_rcp_f32 v133, v133
    v_rcp_f32 v134, v134
    v_rcp_f32 v135, v135
    ds_read_b64_tr_b16 v[168:169], v245 offset:30720
    ds_read_b64_tr_b16 v[170:171], v245 offset:32256
    ds_read_b64_tr_b16 v[172:173], v245 offset:30784
    ds_read_b64_tr_b16 v[174:175], v245 offset:32320
    ds_read_b64_tr_b16 v[176:177], v245 offset:30848
    ds_read_b64_tr_b16 v[178:179], v245 offset:32384
    ds_read_b64_tr_b16 v[180:181], v245 offset:33792
    ds_read_b64_tr_b16 v[182:183], v245 offset:35328
    ds_read_b64_tr_b16 v[184:185], v245 offset:33856
    ds_read_b64_tr_b16 v[186:187], v245 offset:35392
    ds_read_b64_tr_b16 v[188:189], v245 offset:33920
    ds_read_b64_tr_b16 v[190:191], v245 offset:35456
    v_pk_mul_f32 v[120:121], v[88:89], v[120:121]
    v_pk_mul_f32 v[122:123], v[90:91], v[122:123]
    v_pk_mul_f32 v[124:125], v[92:93], v[124:125]
    v_pk_mul_f32 v[126:127], v[94:95], v[126:127]
    v_pk_mul_f32 v[128:129], v[96:97], v[128:129]
    v_pk_mul_f32 v[130:131], v[98:99], v[130:131]
    v_pk_mul_f32 v[132:133], v[100:101], v[132:133]
    v_pk_mul_f32 v[134:135], v[102:103], v[134:135]
    v_pk_fma_f32 v[104:105], v[72:73], v[72:73], s[50:51] neg_lo:[1,0,0] neg_hi:[1,0,0]
    v_pk_fma_f32 v[106:107], v[74:75], v[74:75], s[50:51] neg_lo:[1,0,0] neg_hi:[1,0,0]
    v_pk_fma_f32 v[108:109], v[76:77], v[76:77], s[50:51] neg_lo:[1,0,0] neg_hi:[1,0,0]
    v_pk_fma_f32 v[110:111], v[78:79], v[78:79], s[50:51] neg_lo:[1,0,0] neg_hi:[1,0,0]
    v_pk_fma_f32 v[112:113], v[80:81], v[80:81], s[50:51] neg_lo:[1,0,0] neg_hi:[1,0,0]
    v_pk_fma_f32 v[114:115], v[82:83], v[82:83], s[50:51] neg_lo:[1,0,0] neg_hi:[1,0,0]
    v_pk_fma_f32 v[116:117], v[84:85], v[84:85], s[50:51] neg_lo:[1,0,0] neg_hi:[1,0,0]
    v_pk_fma_f32 v[118:119], v[86:87], v[86:87], s[50:51] neg_lo:[1,0,0] neg_hi:[1,0,0]
    v_pk_mul_f32 v[104:105], v[72:73], v[104:105]
    v_pk_mul_f32 v[106:107], v[74:75], v[106:107]
    v_pk_mul_f32 v[108:109], v[76:77], v[108:109]
    v_pk_mul_f32 v[110:111], v[78:79], v[110:111]
    v_pk_mul_f32 v[112:113], v[80:81], v[112:113]
    v_pk_mul_f32 v[114:115], v[82:83], v[114:115]
    v_pk_mul_f32 v[116:117], v[84:85], v[116:117]
    v_pk_mul_f32 v[118:119], v[86:87], v[118:119]
    v_add_u32 v236, 73728, v236
    v_add_u32 v237, 73728, v237
    v_add_u32 v238, 73728, v238
    v_add_u32 v239, 73728, v239
    v_mfma_f32_32x32x16_bf16 v[88:103], v[144:147], v[48:51], 0
    v_cvt_pk_bf16_f32 v136, v120, v121
    v_cvt_pk_bf16_f32 v137, v122, v123
    v_cvt_pk_bf16_f32 v138, v124, v125
    v_cvt_pk_bf16_f32 v139, v126, v127
    v_exp_f32 v104, v104
    v_mfma_f32_32x32x16_bf16 v[88:103], v[148:151], v[52:55], v[88:103]
    v_cvt_pk_bf16_f32 v140, v128, v129
    v_cvt_pk_bf16_f32 v141, v130, v131
    v_cvt_pk_bf16_f32 v142, v132, v133
    v_cvt_pk_bf16_f32 v143, v134, v135
    v_exp_f32 v105, v105
    v_mfma_f32_32x32x16_bf16 v[88:103], v[152:155], v[56:59], v[88:103]
    v_exp_f32 v106, v106
    v_exp_f32 v107, v107
    v_exp_f32 v108, v108
    v_mfma_f32_32x32x16_bf16 v[88:103], v[156:159], v[60:63], v[88:103]
    v_exp_f32 v109, v109
    v_exp_f32 v110, v110
    v_exp_f32 v111, v111
    v_mfma_f32_32x32x16_bf16 v[88:103], v[160:163], v[64:67], v[88:103]
    v_exp_f32 v112, v112
    v_exp_f32 v113, v113
    v_exp_f32 v114, v114
    v_mfma_f32_32x32x16_bf16 v[88:103], v[164:167], v[68:71], v[88:103]
    s_waitcnt lgkmcnt(0)
    v_exp_f32 v115, v115
    v_exp_f32 v116, v116
    v_exp_f32 v117, v117
    v_mfma_f32_32x32x16_bf16 v[0:15], v[168:171], v[136:139], v[0:15]
    v_exp_f32 v118, v118
    v_exp_f32 v119, v119
    v_mov_b32 v254, 4
    ds_write_b32 v248, v254
    ds_read_b64_tr_b16 v[144:145], v236 offset:0
    ds_read_b64_tr_b16 v[146:147], v236 offset:512
    ds_read_b64_tr_b16 v[148:149], v238 offset:1024
    ds_read_b64_tr_b16 v[150:151], v238 offset:1536
    ds_read_b64_tr_b16 v[152:153], v236 offset:4096
    ds_read_b64_tr_b16 v[154:155], v236 offset:4608
    ds_read_b64_tr_b16 v[156:157], v238 offset:5120
    ds_read_b64_tr_b16 v[158:159], v238 offset:5632
    ds_read_b64_tr_b16 v[160:161], v236 offset:8192
    ds_read_b64_tr_b16 v[162:163], v236 offset:8704
    ds_read_b64_tr_b16 v[164:165], v238 offset:9216
    ds_read_b64_tr_b16 v[166:167], v238 offset:9728
    ds_read_b32 v249, v243 offset:16
    v_pk_fma_f32 v[104:105], v[104:105], s[48:49], s[48:49]
    v_pk_fma_f32 v[106:107], v[106:107], s[48:49], s[48:49]
    v_pk_fma_f32 v[108:109], v[108:109], s[48:49], s[48:49]
    v_pk_fma_f32 v[110:111], v[110:111], s[48:49], s[48:49]
    v_pk_fma_f32 v[112:113], v[112:113], s[48:49], s[48:49]
    v_pk_fma_f32 v[114:115], v[114:115], s[48:49], s[48:49]
    v_pk_fma_f32 v[116:117], v[116:117], s[48:49], s[48:49]
    v_pk_fma_f32 v[118:119], v[118:119], s[48:49], s[48:49]
    v_mfma_f32_32x32x16_bf16 v[16:31], v[172:175], v[136:139], v[16:31]
    v_rcp_f32 v104, v104
    v_rcp_f32 v105, v105
    v_rcp_f32 v106, v106
    v_mfma_f32_32x32x16_bf16 v[32:47], v[176:179], v[136:139], v[32:47]
    v_rcp_f32 v107, v107
    v_rcp_f32 v108, v108
    v_rcp_f32 v109, v109
    v_mfma_f32_32x32x16_bf16 v[0:15], v[180:183], v[140:143], v[0:15]
    v_rcp_f32 v110, v110
    v_rcp_f32 v111, v111
    v_rcp_f32 v112, v112
    v_mfma_f32_32x32x16_bf16 v[16:31], v[184:187], v[140:143], v[16:31]
    v_rcp_f32 v113, v113
    v_rcp_f32 v114, v114
    v_rcp_f32 v115, v115
    v_mfma_f32_32x32x16_bf16 v[32:47], v[188:191], v[140:143], v[32:47]
    s_waitcnt lgkmcnt(0)
    v_rcp_f32 v116, v116
    v_rcp_f32 v117, v117
    v_rcp_f32 v118, v118
    v_rcp_f32 v119, v119
    v_cmp_gt_u32 vcc, 7, v249
    s_cbranch_vccnz L_slow4
L_back4:
    ds_read_b64_tr_b16 v[168:169], v245 offset:49152
    ds_read_b64_tr_b16 v[170:171], v245 offset:50688
    ds_read_b64_tr_b16 v[172:173], v245 offset:49216
    ds_read_b64_tr_b16 v[174:175], v245 offset:50752
    ds_read_b64_tr_b16 v[176:177], v245 offset:49280
    ds_read_b64_tr_b16 v[178:179], v245 offset:50816
    ds_read_b64_tr_b16 v[180:181], v245 offset:52224
    ds_read_b64_tr_b16 v[182:183], v245 offset:53760
    ds_read_b64_tr_b16 v[184:185], v245 offset:52288
    ds_read_b64_tr_b16 v[186:187], v245 offset:53824
    ds_read_b64_tr_b16 v[188:189], v245 offset:52352
    ds_read_b64_tr_b16 v[190:191], v245 offset:53888
    v_pk_mul_f32 v[104:105], v[72:73], v[104:105]
    v_pk_mul_f32 v[106:107], v[74:75], v[106:107]
    v_pk_mul_f32 v[108:109], v[76:77], v[108:109]
    v_pk_mul_f32 v[110:111], v[78:79], v[110:111]
    v_pk_mul_f32 v[112:113], v[80:81], v[112:113]
    v_pk_mul_f32 v[114:115], v[82:83], v[114:115]
    v_pk_mul_f32 v[116:117], v[84:85], v[116:117]
    v_pk_mul_f32 v[118:119], v[86:87], v[118:119]
    v_pk_fma_f32 v[120:121], v[88:89], v[88:89], s[50:51] neg_lo:[1,0,0] neg_hi:[1,0,0]
    v_pk_fma_f32 v[122:123], v[90:91], v[90:91], s[50:51] neg_lo:[1,0,0] neg_hi:[1,0,0]
    v_pk_fma_f32 v[124:125], v[92:93], v[92:93], s[50:51] neg_lo:[1,0,0] neg_hi:[1,0,0]
    v_pk_fma_f32 v[126:127], v[94:95], v[94:95], s[50:51] neg_lo:[1,0,0] neg_hi:[1,0,0]
    v_pk_fma_f32 v[128:129], v[96:97], v[96:97], s[50:51] neg_lo:[1,0,0] neg_hi:[1,0,0]
    v_pk_fma_f32 v[130:131], v[98:99], v[98:99], s[50:51] neg_lo:[1,0,0] neg_hi:[1,0,0]
    v_pk_fma_f32 v[132:133], v[100:101], v[100:101], s[50:51] neg_lo:[1,0,0] neg_hi:[1,0,0]
    v_pk_fma_f32 v[134:135], v[102:103], v[102:103], s[50:51] neg_lo:[1,0,0] neg_hi:[1,0,0]
    v_pk_mul_f32 v[120:121], v[88:89], v[120:121]
    v_pk_mul_f32 v[122:123], v[90:91], v[122:123]
    v_pk_mul_f32 v[124:125], v[92:93], v[124:125]
    v_pk_mul_f32 v[126:127], v[94:95], v[126:127]
    v_pk_mul_f32 v[128:129], v[96:97], v[128:129]
    v_pk_mul_f32 v[130:131], v[98:99], v[130:131]
    v_pk_mul_f32 v[132:133], v[100:101], v[132:133]
    v_pk_mul_f32 v[134:135], v[102:103], v[134:135]
    v_mfma_f32_32x32x16_bf16 v[72:87], v[144:147], v[48:51], 0
    v_cvt_pk_bf16_f32 v136, v104, v105
    v_cvt_pk_bf16_f32 v137, v106, v107
    v_cvt_pk_bf16_f32 v138, v108, v109
    v_cvt_pk_bf16_f32 v139, v110, v111
    v_exp_f32 v120, v120
    v_mfma_f32_32x32x16_bf16 v[72:87], v[148:151], v[52:55], v[72:87]
    v_cvt_pk_bf16_f32 v140, v112, v113
    v_cvt_pk_bf16_f32 v141, v114, v115
    v_cvt_pk_bf16_f32 v142, v116, v117
    v_cvt_pk_bf16_f32 v143, v118, v119
    v_exp_f32 v121, v121
    v_mfma_f32_32x32x16_bf16 v[72:87], v[152:155], v[56:59], v[72:87]
    v_exp_f32 v122, v122
    v_exp_f32 v123, v123
    v_exp_f32 v124, v124
    v_mfma_f32_32x32x16_bf16 v[72:87], v[156:159], v[60:63], v[72:87]
    v_exp_f32 v125, v125
    v_exp_f32 v126, v126
    v_exp_f32 v127, v127
    v_mfma_f32_32x32x16_bf16 v[72:87], v[160:163], v[64:67], v[72:87]
    v_exp_f32 v128, v128
    v_exp_f32 v129, v129
    v_exp_f32 v130, v130
    v_mfma_f32_32x32x16_bf16 v[72:87], v[164:167], v[68:71], v[72:87]
    s_waitcnt lgkmcnt(0)
    v_exp_f32 v131, v131
    v_exp_f32 v132, v132
    v_exp_f32 v133, v133
    v_mfma_f32_32x32x16_bf16 v[0:15], v[168:171], v[136:139], v[0:15]
    v_exp_f32 v134, v134
    v_exp_f32 v135, v135
    ds_read_b64_tr_b16 v[144:145], v237 offset:0
    ds_read_b64_tr_b16 v[146:147], v237 offset:512
    ds_read_b64_tr_b16 v[148:149], v239 offset:1024
    ds_read_b64_tr_b16 v[150:151], v239 offset:1536
    ds_read_b64_tr_b16 v[152:153], v237 offset:4096
    ds_read_b64_tr_b16 v[154:155], v237 offset:4608
    ds_read_b64_tr_b16 v[156:157], v239 offset:5120
    ds_read_b64_tr_b16 v[158:159], v239 offset:5632
    ds_read_b64_tr_b16 v[160:161], v237 offset:8192
    ds_read_b64_tr_b16 v[162:163], v237 offset:8704
    ds_read_b64_tr_b16 v[164:165], v239 offset:9216
    ds_read_b64_tr_b16 v[166:167], v239 offset:9728
    v_pk_fma_f32 v[120:121], v[120:121], s[48:49], s[48:49]
    v_pk_fma_f32 v[122:123], v[122:123], s[48:49], s[48:49]
    v_pk_fma_f32 v[124:125], v[124:125], s[48:49], s[48:49]
    v_pk_fma_f32 v[126:127], v[126:127], s[48:49], s[48:49]
    v_pk_fma_f32 v[128:129], v[128:129], s[48:49], s[48:49]
    v_pk_fma_f32 v[130:131], v[130:131], s[48:49], s[48:49]
    v_pk_fma_f32 v[132:133], v[132:133], s[48:49], s[48:49]
    v_pk_fma_f32 v[134:135], v[134:135], s[48:49], s[48:49]
    v_mfma_f32_32x32x16_bf16 v[16:31], v[172:175], v[136:139], v[16:31]
    v_rcp_f32 v120, v120
    v_rcp_f32 v121, v121
    v_rcp_f32 v122, v122
    v_mfma_f32_32x32x16_bf16 v[32:47], v[176:179], v[136:139], v[32:47]
    v_rcp_f32 v123, v123
    v_rcp_f32 v124, v124
    v_rcp_f32 v125, v125
    v_mfma_f32_32x32x16_bf16 v[0:15], v[180:183], v[140:143], v[0:15]
    v_rcp_f32 v126, v126
    v_rcp_f32 v127, v127
    v_rcp_f32 v128, v128
    v_mfma_f32_32x32x16_bf16 v[16:31], v[184:187], v[140:143], v[16:31]
    v_rcp_f32 v129, v129
    v_rcp_f32 v130, v130
    v_rcp_f32 v131, v131
    v_mfma_f32_32x32x16_bf16 v[32:47], v[188:191], v[140:143], v[32:47]
    s_waitcnt lgkmcnt(0)
    v_rcp_f32 v132, v132
    v_rcp_f32 v133, v133
    v_rcp_f32 v134, v134
    v_rcp_f32 v135, v135
    ds_read_b64_tr_b16 v[168:169], v245 offset:55296
    ds_read_b64_tr_b16 v[170:171], v245 offset:56832
    ds_read_b64_tr_b16 v[172:173], v245 offset:55360
    ds_read_b64_tr_b16 v[174:175], v245 offset:56896
    ds_read_b64_tr_b16 v[176:177], v245 offset:55424
    ds_read_b64_tr_b16 v[178:179], v245 offset:56960
    ds_read_b64_tr_b16 v[180:181], v245 offset:58368
    ds_read_b64_tr_b16 v[182:183], v245 offset:59904
    ds_read_b64_tr_b16 v[184:185], v245 offset:58432
    ds_read_b64_tr_b16 v[186:187], v245 offset:59968
    ds_read_b64_tr_b16 v[188:189], v245 offset:58496
    ds_read_b64_tr_b16 v[190:191], v245 offset:60032
    ds_read_b32 v249, v243 offset:16
    v_pk_mul_f32 v[120:121], v[88:89], v[120:121]
    v_pk_mul_f32 v[122:123], v[90:91], v[122:123]
    v_pk_mul_f32 v[124:125], v[92:93], v[124:125]
    v_pk_mul_f32 v[126:127], v[94:95], v[126:127]
    v_pk_mul_f32 v[128:129], v[96:97], v[128:129]
    v_pk_mul_f32 v[130:131], v[98:99], v[130:131]
    v_pk_mul_f32 v[132:133], v[100:101], v[132:133]
    v_pk_mul_f32 v[134:135], v[102:103], v[134:135]
    v_pk_fma_f32 v[104:105], v[72:73], v[72:73], s[50:51] neg_lo:[1,0,0] neg_hi:[1,0,0]
    v_pk_fma_f32 v[106:107], v[74:75], v[74:75], s[50:51] neg_lo:[1,0,0] neg_hi:[1,0,0]
    v_pk_fma_f32 v[108:109], v[76:77], v[76:77], s[50:51] neg_lo:[1,0,0] neg_hi:[1,0,0]
    v_pk_fma_f32 v[110:111], v[78:79], v[78:79], s[50:51] neg_lo:[1,0,0] neg_hi:[1,0,0]
    v_pk_fma_f32 v[112:113], v[80:81], v[80:81], s[50:51] neg_lo:[1,0,0] neg_hi:[1,0,0]
    v_pk_fma_f32 v[114:115], v[82:83], v[82:83], s[50:51] neg_lo:[1,0,0] neg_hi:[1,0,0]
    v_pk_fma_f32 v[116:117], v[84:85], v[84:85], s[50:51] neg_lo:[1,0,0] neg_hi:[1,0,0]
    v_pk_fma_f32 v[118:119], v[86:87], v[86:87], s[50:51] neg_lo:[1,0,0] neg_hi:[1,0,0]
    v_pk_mul_f32 v[104:105], v[72:73], v[104:105]
    v_pk_mul_f32 v[106:107], v[74:75], v[106:107]
    v_pk_mul_f32 v[108:109], v[76:77], v[108:109]
    v_pk_mul_f32 v[110:111], v[78:79], v[110:111]
    v_pk_mul_f32 v[112:113], v[80:81], v[112:113]
    v_pk_mul_f32 v[114:115], v[82:83], v[114:115]
    v_pk_mul_f32 v[116:117], v[84:85], v[116:117]
    v_pk_mul_f32 v[118:119], v[86:87], v[118:119]
    v_add_u32 v245, 73728, v245
    v_mfma_f32_32x32x16_bf16 v[88:103], v[144:147], v[48:51], 0
    v_cvt_pk_bf16_f32 v136, v120, v121
    v_cvt_pk_bf16_f32 v137, v122, v123
    v_cvt_pk_bf16_f32 v138, v124, v125
    v_cvt_pk_bf16_f32 v139, v126, v127
    v_exp_f32 v104, v104
    v_mfma_f32_32x32x16_bf16 v[88:103], v[148:151], v[52:55], v[88:103]
    v_cvt_pk_bf16_f32 v140, v128, v129
    v_cvt_pk_bf16_f32 v141, v130, v131
    v_cvt_pk_bf16_f32 v142, v132, v133
    v_cvt_pk_bf16_f32 v143, v134, v135
    v_exp_f32 v105, v105
    v_mfma_f32_32x32x16_bf16 v[88:103], v[152:155], v[56:59], v[88:103]
    v_exp_f32 v106, v106
    v_exp_f32 v107, v107
    v_exp_f32 v108, v108
    v_mfma_f32_32x32x16_bf16 v[88:103], v[156:159], v[60:63], v[88:103]
    v_exp_f32 v109, v109
    v_exp_f32 v110, v110
    v_exp_f32 v111, v111
    v_mfma_f32_32x32x16_bf16 v[88:103], v[160:163], v[64:67], v[88:103]
    v_exp_f32 v112, v112
    v_exp_f32 v113, v113
    v_exp_f32 v114, v114
    v_mfma_f32_32x32x16_bf16 v[88:103], v[164:167], v[68:71], v[88:103]
    s_waitcnt lgkmcnt(0)
    v_exp_f32 v115, v115
    v_exp_f32 v116, v116
    v_exp_f32 v117, v117
    v_mfma_f32_32x32x16_bf16 v[0:15], v[168:171], v[136:139], v[0:15]
    v_exp_f32 v118, v118
    v_exp_f32 v119, v119
    v_cmp_gt_u32 vcc, 8, v249
    s_cbranch_vccnz L_slow5
L_back5:
    ds_read_b64_tr_b16 v[144:145], v236 offset:24576
    ds_read_b64_tr_b16 v[146:147], v236 offset:25088
    ds_read_b64_tr_b16 v[148:149], v238 offset:25600
    ds_read_b64_tr_b16 v[150:151], v238 offset:26112
    ds_read_b64_tr_b16 v[152:153], v236 offset:28672
    ds_read_b64_tr_b16 v[154:155], v236 offset:29184
    ds_read_b64_tr_b16 v[156:157], v238 offset:29696
    ds_read_b64_tr_b16 v[158:159], v238 offset:30208
    ds_read_b64_tr_b16 v[160:161], v236 offset:32768
    ds_read_b64_tr_b16 v[162:163], v236 offset:33280
    ds_read_b64_tr_b16 v[164:165], v238 offset:33792
    ds_read_b64_tr_b16 v[166:167], v238 offset:34304
    v_pk_fma_f32 v[104:105], v[104:105], s[48:49], s[48:49]
    v_pk_fma_f32 v[106:107], v[106:107], s[48:49], s[48:49]
    v_pk_fma_f32 v[108:109], v[108:109], s[48:49], s[48:49]
    v_pk_fma_f32 v[110:111], v[110:111], s[48:49], s[48:49]
    v_pk_fma_f32 v[112:113], v[112:113], s[48:49], s[48:49]
    v_pk_fma_f32 v[114:115], v[114:115], s[48:49], s[48:49]
    v_pk_fma_f32 v[116:117], v[116:117], s[48:49], s[48:49]
    v_pk_fma_f32 v[118:119], v[118:119], s[48:49], s[48:49]
    v_mfma_f32_32x32x16_bf16 v[16:31], v[172:175], v[136:139], v[16:31]
    v_rcp_f32 v104, v104
    v_rcp_f32 v105, v105
    v_rcp_f32 v106, v106
    v_mfma_f32_32x32x16_bf16 v[32:47], v[176:179], v[136:139], v[32:47]
    v_rcp_f32 v107, v107
    v_rcp_f32 v108, v108
    v_rcp_f32 v109, v109
    v_mfma_f32_32x32x16_bf16 v[0:15], v[180:183], v[140:143], v[0:15]
    v_rcp_f32 v110, v110
    v_rcp_f32 v111, v111
    v_rcp_f32 v112, v112
    v_mfma_f32_32x32x16_bf16 v[16:31], v[184:187], v[140:143], v[16:31]
    v_rcp_f32 v113, v113
    v_rcp_f32 v114, v114
    v_rcp_f32 v115, v115
    v_mfma_f32_32x32x16_bf16 v[32:47], v[188:191], v[140:143], v[32:47]
    s_waitcnt lgkmcnt(0)
    v_rcp_f32 v116, v116
    v_rcp_f32 v117, v117
    v_rcp_f32 v118, v118
    v_rcp_f32 v119, v119
    ds_read_b64_tr_b16 v[168:169], v245 offset:0
    ds_read_b64_tr_b16 v[170:171], v245 offset:1536
    ds_read_b64_tr_b16 v[172:173], v245 offset:64
    ds_read_b64_tr_b16 v[174:175], v245 offset:1600
    ds_read_b64_tr_b16 v[176:177], v245 offset:128
    ds_read_b64_tr_b16 v[178:179], v245 offset:1664
    ds_read_b64_tr_b16 v[180:181], v245 offset:3072
    ds_read_b64_tr_b16 v[182:183], v245 offset:4608
    ds_read_b64_tr_b16 v[184:185], v245 offset:3136
    ds_read_b64_tr_b16 v[186:187], v245 offset:4672
    ds_read_b64_tr_b16 v[188:189], v245 offset:3200
    ds_read_b64_tr_b16 v[190:191], v245 offset:4736
    v_pk_mul_f32 v[104:105], v[72:73], v[104:105]
    v_pk_mul_f32 v[106:107], v[74:75], v[106:107]
    v_pk_mul_f32 v[108:109], v[76:77], v[108:109]
    v_pk_mul_f32 v[110:111], v[78:79], v[110:111]
    v_pk_mul_f32 v[112:113], v[80:81], v[112:113]
    v_pk_mul_f32 v[114:115], v[82:83], v[114:115]
    v_pk_mul_f32 v[116:117], v[84:85], v[116:117]
    v_pk_mul_f32 v[118:119], v[86:87], v[118:119]
    v_pk_fma_f32 v[120:121], v[88:89], v[88:89], s[50:51] neg_lo:[1,0,0] neg_hi:[1,0,0]
    v_pk_fma_f32 v[122:123], v[90:91], v[90:91], s[50:51] neg_lo:[1,0,0] neg_hi:[1,0,0]
    v_pk_fma_f32 v[124:125], v[92:93], v[92:93], s[50:51] neg_lo:[1,0,0] neg_hi:[1,0,0]
    v_pk_fma_f32 v[126:127], v[94:95], v[94:95], s[50:51] neg_lo:[1,0,0] neg_hi:[1,0,0]
    v_pk_fma_f32 v[128:129], v[96:97], v[96:97], s[50:51] neg_lo:[1,0,0] neg_hi:[1,0,0]
    v_pk_fma_f32 v[130:131], v[98:99], v[98:99], s[50:51] neg_lo:[1,0,0] neg_hi:[1,0,0]
    v_pk_fma_f32 v[132:133], v[100:101], v[100:101], s[50:51] neg_lo:[1,0,0] neg_hi:[1,0,0]
    v_pk_fma_f32 v[134:135], v[102:103], v[102:103], s[50:51] neg_lo:[1,0,0] neg_hi:[1,0,0]
    v_pk_mul_f32 v[120:121], v[88:89], v[120:121]
    v_pk_mul_f32 v[122:123], v[90:91], v[122:123]
    v_pk_mul_f32 v[124:125], v[92:93], v[124:125]
    v_pk_mul_f32 v[126:127], v[94:95], v[126:127]
    v_pk_mul_f32 v[128:129], v[96:97], v[128:129]
    v_pk_mul_f32 v[130:131], v[98:99], v[130:131]
    v_pk_mul_f32 v[132:133], v[100:101], v[132:133]
    v_pk_mul_f32 v[134:135], v[102:103], v[134:135]
    v_mfma_f32_32x32x16_bf16 v[72:87], v[144:147], v[48:51], 0
    v_cvt_pk_bf16_f32 v136, v104, v105
    v_cvt_pk_bf16_f32 v137, v106, v107
    v_cvt_pk_bf16_f32 v138, v108, v109
    v_cvt_pk_bf16_f32 v139, v110, v111
    v_exp_f32 v120, v120
    v_mfma_f32_32x32x16_bf16 v[72:87], v[148:151], v[52:55], v[72:87]
    v_cvt_pk_bf16_f32 v140, v112, v113
    v_cvt_pk_bf16_f32 v141, v114, v115
    v_cvt_pk_bf16_f32 v142, v116, v117
    v_cvt_pk_bf16_f32 v143, v118, v119
    v_exp_f32 v121, v121
    v_mfma_f32_32x32x16_bf16 v[72:87], v[152:155], v[56:59], v[72:87]
    v_exp_f32 v122, v122
    v_exp_f32 v123, v123
    v_exp_f32 v124, v124
    v_mfma_f32_32x32x16_bf16 v[72:87], v[156:159], v[60:63], v[72:87]
    v_exp_f32 v125, v125
    v_exp_f32 v126, v126
    v_exp_f32 v127, v127
    v_mfma_f32_32x32x16_bf16 v[72:87], v[160:163], v[64:67], v[72:87]
    v_exp_f32 v128, v128
    v_exp_f32 v129, v129
    v_exp_f32 v130, v130
    v_mfma_f32_32x32x16_bf16 v[72:87], v[164:167], v[68:71], v[72:87]
    s_waitcnt lgkmcnt(0)
    v_exp_f32 v131, v131
    v_exp_f32 v132, v132
    v_exp_f32 v133, v133
    v_mfma_f32_32x32x16_bf16 v[0:15], v[168:171], v[136:139], v[0:15]
    v_exp_f32 v134, v134
    v_exp_f32 v135, v135
    ds_read_b64_tr_b16 v[144:145], v237 offset:24576
    ds_read_b64_tr_b16 v[146:147], v237 offset:25088
    ds_read_b64_tr_b16 v[148:149], v239 offset:25600
    ds_read_b64_tr_b16 v[150:151], v239 offset:26112
    ds_read_b64_tr_b16 v[152:153], v237 offset:28672
    ds_read_b64_tr_b16 v[154:155], v237 offset:29184
    ds_read_b64_tr_b16 v[156:157], v239 offset:29696
    ds_read_b64_tr_b16 v[158:159], v239 offset:30208
    ds_read_b64_tr_b16 v[160:161], v237 offset:32768
    ds_read_b64_tr_b16 v[162:163], v237 offset:33280
    ds_read_b64_tr_b16 v[164:165], v239 offset:33792
    ds_read_b64_tr_b16 v[166:167], v239 offset:34304
    v_pk_fma_f32 v[120:121], v[120:121], s[48:49], s[48:49]
    v_pk_fma_f32 v[122:123], v[122:123], s[48:49], s[48:49]
    v_pk_fma_f32 v[124:125], v[124:125], s[48:49], s[48:49]
    v_pk_fma_f32 v[126:127], v[126:127], s[48:49], s[48:49]
    v_pk_fma_f32 v[128:129], v[128:129], s[48:49], s[48:49]
    v_pk_fma_f32 v[130:131], v[130:131], s[48:49], s[48:49]
    v_pk_fma_f32 v[132:133], v[132:133], s[48:49], s[48:49]
    v_pk_fma_f32 v[134:135], v[134:135], s[48:49], s[48:49]
    v_mfma_f32_32x32x16_bf16 v[16:31], v[172:175], v[136:139], v[16:31]
    v_rcp_f32 v120, v120
    v_rcp_f32 v121, v121
    v_rcp_f32 v122, v122
    v_mfma_f32_32x32x16_bf16 v[32:47], v[176:179], v[136:139], v[32:47]
    v_rcp_f32 v123, v123
    v_rcp_f32 v124, v124
    v_rcp_f32 v125, v125
    v_mfma_f32_32x32x16_bf16 v[0:15], v[180:183], v[140:143], v[0:15]
    v_rcp_f32 v126, v126
    v_rcp_f32 v127, v127
    v_rcp_f32 v128, v128
    v_mfma_f32_32x32x16_bf16 v[16:31], v[184:187], v[140:143], v[16:31]
    v_rcp_f32 v129, v129
    v_rcp_f32 v130, v130
    v_rcp_f32 v131, v131
    v_mfma_f32_32x32x16_bf16 v[32:47], v[188:191], v[140:143], v[32:47]
    s_waitcnt lgkmcnt(0)
    v_rcp_f32 v132, v132
    v_rcp_f32 v133, v133
    v_rcp_f32 v134, v134
    v_rcp_f32 v135, v135
    ds_read_b64_tr_b16 v[168:169], v245 offset:6144
    ds_read_b64_tr_b16 v[170:171], v245 offset:7680
    ds_read_b64_tr_b16 v[172:173], v245 offset:6208
    ds_read_b64_tr_b16 v[174:175], v245 offset:7744
    ds_read_b64_tr_b16 v[176:177], v245 offset:6272
    ds_read_b64_tr_b16 v[178:179], v245 offset:7808
    ds_read_b64_tr_b16 v[180:181], v245 offset:9216
    ds_read_b64_tr_b16 v[182:183], v245 offset:10752
    ds_read_b64_tr_b16 v[184:185], v245 offset:9280
    ds_read_b64_tr_b16 v[186:187], v245 offset:10816
    ds_read_b64_tr_b16 v[188:189], v245 offset:9344
    ds_read_b64_tr_b16 v[190:191], v245 offset:10880
    v_pk_mul_f32 v[120:121], v[88:89], v[120:121]
    v_pk_mul_f32 v[122:123], v[90:91], v[122:123]
    v_pk_mul_f32 v[124:125], v[92:93], v[124:125]
    v_pk_mul_f32 v[126:127], v[94:95], v[126:127]
    v_pk_mul_f32 v[128:129], v[96:97], v[128:129]
    v_pk_mul_f32 v[130:131], v[98:99], v[130:131]
    v_pk_mul_f32 v[132:133], v[100:101], v[132:133]
    v_pk_mul_f32 v[134:135], v[102:103], v[134:135]
    v_pk_fma_f32 v[104:105], v[72:73], v[72:73], s[50:51] neg_lo:[1,0,0] neg_hi:[1,0,0]
    v_pk_fma_f32 v[106:107], v[74:75], v[74:75], s[50:51] neg_lo:[1,0,0] neg_hi:[1,0,0]
    v_pk_fma_f32 v[108:109], v[76:77], v[76:77], s[50:51] neg_lo:[1,0,0] neg_hi:[1,0,0]
    v_pk_fma_f32 v[110:111], v[78:79], v[78:79], s[50:51] neg_lo:[1,0,0] neg_hi:[1,0,0]
    v_pk_fma_f32 v[112:113], v[80:81], v[80:81], s[50:51] neg_lo:[1,0,0] neg_hi:[1,0,0]
    v_pk_fma_f32 v[114:115], v[82:83], v[82:83], s[50:51] neg_lo:[1,0,0] neg_hi:[1,0,0]
    v_pk_fma_f32 v[116:117], v[84:85], v[84:85], s[50:51] neg_lo:[1,0,0] neg_hi:[1,0,0]
    v_pk_fma_f32 v[118:119], v[86:87], v[86:87], s[50:51] neg_lo:[1,0,0] neg_hi:[1,0,0]
    v_pk_mul_f32 v[104:105], v[72:73], v[104:105]
    v_pk_mul_f32 v[106:107], v[74:75], v[106:107]
    v_pk_mul_f32 v[108:109], v[76:77], v[108:109]
    v_pk_mul_f32 v[110:111], v[78:79], v[110:111]
    v_pk_mul_f32 v[112:113], v[80:81], v[112:113]
    v_pk_mul_f32 v[114:115], v[82:83], v[114:115]
    v_pk_mul_f32 v[116:117], v[84:85], v[116:117]
    v_pk_mul_f32 v[118:119], v[86:87], v[118:119]
    v_mfma_f32_32x32x16_bf16 v[88:103], v[144:147], v[48:51], 0
    v_cvt_pk_bf16_f32 v136, v120, v121
    v_cvt_pk_bf16_f32 v137, v122, v123
    v_cvt_pk_bf16_f32 v138, v124, v125
    v_cvt_pk_bf16_f32 v139, v126, v127
    v_exp_f32 v104, v104
    v_mfma_f32_32x32x16_bf16 v[88:103], v[148:151], v[52:55], v[88:103]
    v_cvt_pk_bf16_f32 v140, v128, v129
    v_cvt_pk_bf16_f32 v141, v130, v131
    v_cvt_pk_bf16_f32 v142, v132, v133
    v_cvt_pk_bf16_f32 v143, v134, v135
    v_exp_f32 v105, v105
    v_mfma_f32_32x32x16_bf16 v[88:103], v[152:155], v[56:59], v[88:103]
    v_exp_f32 v106, v106
    v_exp_f32 v107, v107
    v_exp_f32 v108, v108
    v_mfma_f32_32x32x16_bf16 v[88:103], v[156:159], v[60:63], v[88:103]
    v_exp_f32 v109, v109
    v_exp_f32 v110, v110
    v_exp_f32 v111, v111
    v_mfma_f32_32x32x16_bf16 v[88:103], v[160:163], v[64:67], v[88:103]
    v_exp_f32 v112, v112
    v_exp_f32 v113, v113
    v_exp_f32 v114, v114
    v_mfma_f32_32x32x16_bf16 v[88:103], v[164:167], v[68:71], v[88:103]
    s_waitcnt lgkmcnt(0)
    v_exp_f32 v115, v115
    v_exp_f32 v116, v116
    v_exp_f32 v117, v117
    v_mfma_f32_32x32x16_bf16 v[0:15], v[168:171], v[136:139], v[0:15]
    v_exp_f32 v118, v118
    v_exp_f32 v119, v119
    ds_read_b64_tr_b16 v[144:145], v236 offset:49152
    ds_read_b64_tr_b16 v[146:147], v236 offset:49664
    ds_read_b64_tr_b16 v[148:149], v238 offset:50176
    ds_read_b64_tr_b16 v[150:151], v238 offset:50688
    ds_read_b64_tr_b16 v[152:153], v236 offset:53248
    ds_read_b64_tr_b16 v[154:155], v236 offset:53760
    ds_read_b64_tr_b16 v[156:157], v238 offset:54272
    ds_read_b64_tr_b16 v[158:159], v238 offset:54784
    ds_read_b64_tr_b16 v[160:161], v236 offset:57344
    ds_read_b64_tr_b16 v[162:163], v236 offset:57856
    ds_read_b64_tr_b16 v[164:165], v238 offset:58368
    ds_read_b64_tr_b16 v[166:167], v238 offset:58880
    v_pk_fma_f32 v[104:105], v[104:105], s[48:49], s[48:49]
    v_pk_fma_f32 v[106:107], v[106:107], s[48:49], s[48:49]
    v_pk_fma_f32 v[108:109], v[108:109], s[48:49], s[48:49]
    v_pk_fma_f32 v[110:111], v[110:111], s[48:49], s[48:49]
    v_pk_fma_f32 v[112:113], v[112:113], s[48:49], s[48:49]
    v_pk_fma_f32 v[114:115], v[114:115], s[48:49], s[48:49]
    v_pk_fma_f32 v[116:117], v[116:117], s[48:49], s[48:49]
    v_pk_fma_f32 v[118:119], v[118:119], s[48:49], s[48:49]
    v_mfma_f32_32x32x16_bf16 v[16:31], v[172:175], v[136:139], v[16:31]
    v_rcp_f32 v104, v104
    v_rcp_f32 v105, v105
    v_rcp_f32 v106, v106
    v_mfma_f32_32x32x16_bf16 v[32:47], v[176:179], v[136:139], v[32:47]
    v_rcp_f32 v107, v107
    v_rcp_f32 v108, v108
    v_rcp_f32 v109, v109
    v_mfma_f32_32x32x16_bf16 v[0:15], v[180:183], v[140:143], v[0:15]
    v_rcp_f32 v110, v110
    v_rcp_f32 v111, v111
    v_rcp_f32 v112, v112
    v_mfma_f32_32x32x16_bf16 v[16:31], v[184:187], v[140:143], v[16:31]
    v_rcp_f32 v113, v113
    v_rcp_f32 v114, v114
    v_rcp_f32 v115, v115
    v_mfma_f32_32x32x16_bf16 v[32:47], v[188:191], v[140:143], v[32:47]
    s_waitcnt lgkmcnt(0)
    v_rcp_f32 v116, v116
    v_rcp_f32 v117, v117
    v_rcp_f32 v118, v118
    v_rcp_f32 v119, v119
    ds_read_b64_tr_b16 v[168:169], v245 offset:24576
    ds_read_b64_tr_b16 v[170:171], v245 offset:26112
    ds_read_b64_tr_b16 v[172:173], v245 offset:24640
    ds_read_b64_tr_b16 v[174:175], v245 offset:26176
    ds_read_b64_tr_b16 v[176:177], v245 offset:24704
    ds_read_b64_tr_b16 v[178:179], v245 offset:26240
    ds_read_b64_tr_b16 v[180:181], v245 offset:27648
    ds_read_b64_tr_b16 v[182:183], v245 offset:29184
    ds_read_b64_tr_b16 v[184:185], v245 offset:27712
    ds_read_b64_tr_b16 v[186:187], v245 offset:29248
    ds_read_b64_tr_b16 v[188:189], v245 offset:27776
    ds_read_b64_tr_b16 v[190:191], v245 offset:29312
    ds_read_b32 v249, v243 offset:0
    v_pk_mul_f32 v[104:105], v[72:73], v[104:105]
    v_pk_mul_f32 v[106:107], v[74:75], v[106:107]
    v_pk_mul_f32 v[108:109], v[76:77], v[108:109]
    v_pk_mul_f32 v[110:111], v[78:79], v[110:111]
    v_pk_mul_f32 v[112:113], v[80:81], v[112:113]
    v_pk_mul_f32 v[114:115], v[82:83], v[114:115]
    v_pk_mul_f32 v[116:117], v[84:85], v[116:117]
    v_pk_mul_f32 v[118:119], v[86:87], v[118:119]
    v_pk_fma_f32 v[120:121], v[88:89], v[88:89], s[50:51] neg_lo:[1,0,0] neg_hi:[1,0,0]
    v_pk_fma_f32 v[122:123], v[90:91], v[90:91], s[50:51] neg_lo:[1,0,0] neg_hi:[1,0,0]
    v_pk_fma_f32 v[124:125], v[92:93], v[92:93], s[50:51] neg_lo:[1,0,0] neg_hi:[1,0,0]
    v_pk_fma_f32 v[126:127], v[94:95], v[94:95], s[50:51] neg_lo:[1,0,0] neg_hi:[1,0,0]
    v_pk_fma_f32 v[128:129], v[96:97], v[96:97], s[50:51] neg_lo:[1,0,0] neg_hi:[1,0,0]
    v_pk_fma_f32 v[130:131], v[98:99], v[98:99], s[50:51] neg_lo:[1,0,0] neg_hi:[1,0,0]
    v_pk_fma_f32 v[132:133], v[100:101], v[100:101], s[50:51] neg_lo:[1,0,0] neg_hi:[1,0,0]
    v_pk_fma_f32 v[134:135], v[102:103], v[102:103], s[50:51] neg_lo:[1,0,0] neg_hi:[1,0,0]
    v_pk_mul_f32 v[120:121], v[88:89], v[120:121]
    v_pk_mul_f32 v[122:123], v[90:91], v[122:123]
    v_pk_mul_f32 v[124:125], v[92:93], v[124:125]
    v_pk_mul_f32 v[126:127], v[94:95], v[126:127]
    v_pk_mul_f32 v[128:129], v[96:97], v[128:129]
    v_pk_mul_f32 v[130:131], v[98:99], v[130:131]
    v_pk_mul_f32 v[132:133], v[100:101], v[132:133]
    v_pk_mul_f32 v[134:135], v[102:103], v[134:135]
    v_mfma_f32_32x32x16_bf16 v[72:87], v[144:147], v[48:51], 0
    v_cvt_pk_bf16_f32 v136, v104, v105
    v_cvt_pk_bf16_f32 v137, v106, v107
    v_cvt_pk_bf16_f32 v138, v108, v109
    v_cvt_pk_bf16_f32 v139, v110, v111
    v_exp_f32 v120, v120
    v_mfma_f32_32x32x16_bf16 v[72:87], v[148:151], v[52:55], v[72:87]
    v_cvt_pk_bf16_f32 v140, v112, v113
    v_cvt_pk_bf16_f32 v141, v114, v115
    v_cvt_pk_bf16_f32 v142, v116, v117
    v_cvt_pk_bf16_f32 v143, v118, v119
    v_exp_f32 v121, v121
    v_mfma_f32_32x32x16_bf16 v[72:87], v[152:155], v[56:59], v[72:87]
    v_exp_f32 v122, v122
    v_exp_f32 v123, v123
    v_exp_f32 v124, v124
    v_mfma_f32_32x32x16_bf16 v[72:87], v[156:159], v[60:63], v[72:87]
    v_exp_f32 v125, v125
    v_exp_f32 v126, v126
    v_exp_f32 v127, v127
    v_mfma_f32_32x32x16_bf16 v[72:87], v[160:163], v[64:67], v[72:87]
    v_exp_f32 v128, v128
    v_exp_f32 v129, v129
    v_exp_f32 v130, v130
    v_mfma_f32_32x32x16_bf16 v[72:87], v[164:167], v[68:71], v[72:87]
    s_waitcnt lgkmcnt(0)
    v_exp_f32 v131, v131
    v_exp_f32 v132, v132
    v_exp_f32 v133, v133
    v_mfma_f32_32x32x16_bf16 v[0:15], v[168:171], v[136:139], v[0:15]
    v_exp_f32 v134, v134
    v_exp_f32 v135, v135
    v_cmp_gt_u32 vcc, 4, v249
    s_cbranch_vccnz L_slow6
L_back6:
    ds_read_b64_tr_b16 v[144:145], v237 offset:49152
    ds_read_b64_tr_b16 v[146:147], v237 offset:49664
    ds_read_b64_tr_b16 v[148:149], v239 offset:50176
    ds_read_b64_tr_b16 v[150:151], v239 offset:50688
    ds_read_b64_tr_b16 v[152:153], v237 offset:53248
    ds_read_b64_tr_b16 v[154:155], v237 offset:53760
    ds_read_b64_tr_b16 v[156:157], v239 offset:54272
    ds_read_b64_tr_b16 v[158:159], v239 offset:54784
    ds_read_b64_tr_b16 v[160:161], v237 offset:57344
    ds_read_b64_tr_b16 v[162:163], v237 offset:57856
    ds_read_b64_tr_b16 v[164:165], v239 offset:58368
    ds_read_b64_tr_b16 v[166:167], v239 offset:58880
    v_pk_fma_f32 v[120:121], v[120:121], s[48:49], s[48:49]
    v_pk_fma_f32 v[122:123], v[122:123], s[48:49], s[48:49]
    v_pk_fma_f32 v[124:125], v[124:125], s[48:49], s[48:49]
    v_pk_fma_f32 v[126:127], v[126:127], s[48:49], s[48:49]
    v_pk_fma_f32 v[128:129], v[128:129], s[48:49], s[48:49]
    v_pk_fma_f32 v[130:131], v[130:131], s[48:49], s[48:49]
    v_pk_fma_f32 v[132:133], v[132:133], s[48:49], s[48:49]
    v_pk_fma_f32 v[134:135], v[134:135], s[48:49], s[48:49]
    v_mfma_f32_32x32x16_bf16 v[16:31], v[172:175], v[136:139], v[16:31]
    v_rcp_f32 v120, v120
    v_rcp_f32 v121, v121
    v_rcp_f32 v122, v122
    v_mfma_f32_32x32x16_bf16 v[32:47], v[176:179], v[136:139], v[32:47]
    v_rcp_f32 v123, v123
    v_rcp_f32 v124, v124
    v_rcp_f32 v125, v125
    v_mfma_f32_32x32x16_bf16 v[0:15], v[180:183], v[140:143], v[0:15]
    v_rcp_f32 v126, v126
    v_rcp_f32 v127, v127
    v_rcp_f32 v128, v128
    v_mfma_f32_32x32x16_bf16 v[16:31], v[184:187], v[140:143], v[16:31]
    v_rcp_f32 v129, v129
    v_rcp_f32 v130, v130
    v_rcp_f32 v131, v131
    v_mfma_f32_32x32x16_bf16 v[32:47], v[188:191], v[140:143], v[32:47]
    s_waitcnt lgkmcnt(0)
    v_rcp_f32 v132, v132
    v_rcp_f32 v133, v133
    v_rcp_f32 v134, v134
    v_rcp_f32 v135, v135
    ds_read_b64_tr_b16 v[168:169], v245 offset:30720
    ds_read_b64_tr_b16 v[170:171], v245 offset:32256
    ds_read_b64_tr_b16 v[172:173], v245 offset:30784
    ds_read_b64_tr_b16 v[174:175], v245 offset:32320
    ds_read_b64_tr_b16 v[176:177], v245 offset:30848
    ds_read_b64_tr_b16 v[178:179], v245 offset:32384
    ds_read_b64_tr_b16 v[180:181], v245 offset:33792
    ds_read_b64_tr_b16 v[182:183], v245 offset:35328
    ds_read_b64_tr_b16 v[184:185], v245 offset:33856
    ds_read_b64_tr_b16 v[186:187], v245 offset:35392
    ds_read_b64_tr_b16 v[188:189], v245 offset:33920
    ds_read_b64_tr_b16 v[190:191], v245 offset:35456
    v_pk_mul_f32 v[120:121], v[88:89], v[120:121]
    v_pk_mul_f32 v[122:123], v[90:91], v[122:123]
    v_pk_mul_f32 v[124:125], v[92:93], v[124:125]
    v_pk_mul_f32 v[126:127], v[94:95], v[126:127]
    v_pk_mul_f32 v[128:129], v[96:97], v[128:129]
    v_pk_mul_f32 v[130:131], v[98:99], v[130:131]
    v_pk_mul_f32 v[132:133], v[100:101], v[132:133]
    v_pk_mul_f32 v[134:135], v[102:103], v[134:135]
    v_pk_fma_f32 v[104:105], v[72:73], v[72:73], s[50:51] neg_lo:[1,0,0] neg_hi:[1,0,0]
    v_pk_fma_f32 v[106:107], v[74:75], v[74:75], s[50:51] neg_lo:[1,0,0] neg_hi:[1,0,0]
    v_pk_fma_f32 v[108:109], v[76:77], v[76:77], s[50:51] neg_lo:[1,0,0] neg_hi:[1,0,0]
    v_pk_fma_f32 v[110:111], v[78:79], v[78:79], s[50:51] neg_lo:[1,0,0] neg_hi:[1,0,0]
    v_pk_fma_f32 v[112:113], v[80:81], v[80:81], s[50:51] neg_lo:[1,0,0] neg_hi:[1,0,0]
    v_pk_fma_f32 v[114:115], v[82:83], v[82:83], s[50:51] neg_lo:[1,0,0] neg_hi:[1,0,0]
    v_pk_fma_f32 v[116:117], v[84:85], v[84:85], s[50:51] neg_lo:[1,0,0] neg_hi:[1,0,0]
    v_pk_fma_f32 v[118:119], v[86:87], v[86:87], s[50:51] neg_lo:[1,0,0] neg_hi:[1,0,0]
    v_pk_mul_f32 v[104:105], v[72:73], v[104:105]
    v_pk_mul_f32 v[106:107], v[74:75], v[106:107]
    v_pk_mul_f32 v[108:109], v[76:77], v[108:109]
    v_pk_mul_f32 v[110:111], v[78:79], v[110:111]
    v_pk_mul_f32 v[112:113], v[80:81], v[112:113]
    v_pk_mul_f32 v[114:115], v[82:83], v[114:115]
    v_pk_mul_f32 v[116:117], v[84:85], v[116:117]
    v_pk_mul_f32 v[118:119], v[86:87], v[118:119]
    v_mfma_f32_32x32x16_bf16 v[88:103], v[144:147], v[48:51], 0
    v_cvt_pk_bf16_f32 v136, v120, v121
    v_cvt_pk_bf16_f32 v137, v122, v123
    v_cvt_pk_bf16_f32 v138, v124, v125
    v_cvt_pk_bf16_f32 v139, v126, v127
    v_exp_f32 v104, v104
    v_mfma_f32_32x32x16_bf16 v[88:103], v[148:151], v[52:55], v[88:103]
    v_cvt_pk_bf16_f32 v140, v128, v129
    v_cvt_pk_bf16_f32 v141, v130, v131
    v_cvt_pk_bf16_f32 v142, v132, v133
    v_cvt_pk_bf16_f32 v143, v134, v135
    v_exp_f32 v105, v105
    v_mfma_f32_32x32x16_bf16 v[88:103], v[152:155], v[56:59], v[88:103]
    v_exp_f32 v106, v106
    v_exp_f32 v107, v107
    v_exp_f32 v108, v108
    v_mfma_f32_32x32x16_bf16 v[88:103], v[156:159], v[60:63], v[88:103]
    v_exp_f32 v109, v109
    v_exp_f32 v110, v110
    v_exp_f32 v111, v111
    v_mfma_f32_32x32x16_bf16 v[88:103], v[160:163], v[64:67], v[88:103]
    v_exp_f32 v112, v112
    v_exp_f32 v113, v113
    v_exp_f32 v114, v114
    v_mfma_f32_32x32x16_bf16 v[88:103], v[164:167], v[68:71], v[88:103]
    s_waitcnt lgkmcnt(0)
    v_exp_f32 v115, v115
    v_exp_f32 v116, v116
    v_exp_f32 v117, v117
    v_mfma_f32_32x32x16_bf16 v[0:15], v[168:171], v[136:139], v[0:15]
    v_exp_f32 v118, v118
    v_exp_f32 v119, v119
    v_pk_fma_f32 v[104:105], v[104:105], s[48:49], s[48:49]
    v_pk_fma_f32 v[106:107], v[106:107], s[48:49], s[48:49]
    v_pk_fma_f32 v[108:109], v[108:109], s[48:49], s[48:49]
    v_pk_fma_f32 v[110:111], v[110:111], s[48:49], s[48:49]
    v_pk_fma_f32 v[112:113], v[112:113], s[48:49], s[48:49]
    v_pk_fma_f32 v[114:115], v[114:115], s[48:49], s[48:49]
    v_pk_fma_f32 v[116:117], v[116:117], s[48:49], s[48:49]
    v_pk_fma_f32 v[118:119], v[118:119], s[48:49], s[48:49]
    v_mfma_f32_32x32x16_bf16 v[16:31], v[172:175], v[136:139], v[16:31]
    v_rcp_f32 v104, v104
    v_rcp_f32 v105, v105
    v_rcp_f32 v106, v106
    v_mfma_f32_32x32x16_bf16 v[32:47], v[176:179], v[136:139], v[32:47]
    v_rcp_f32 v107, v107
    v_rcp_f32 v108, v108
    v_rcp_f32 v109, v109
    v_mfma_f32_32x32x16_bf16 v[0:15], v[180:183], v[140:143], v[0:15]
    v_rcp_f32 v110, v110
    v_rcp_f32 v111, v111
    v_rcp_f32 v112, v112
    v_mfma_f32_32x32x16_bf16 v[16:31], v[184:187], v[140:143], v[16:31]
    v_rcp_f32 v113, v113
    v_rcp_f32 v114, v114
    v_rcp_f32 v115, v115
    v_mfma_f32_32x32x16_bf16 v[32:47], v[188:191], v[140:143], v[32:47]
    s_waitcnt lgkmcnt(0)
    v_rcp_f32 v116, v116
    v_rcp_f32 v117, v117
    v_rcp_f32 v118, v118
    v_rcp_f32 v119, v119
    ds_read_b64_tr_b16 v[168:169], v245 offset:49152
    ds_read_b64_tr_b16 v[170:171], v245 offset:50688
    ds_read_b64_tr_b16 v[172:173], v245 offset:49216
    ds_read_b64_tr_b16 v[174:175], v245 offset:50752
    ds_read_b64_tr_b16 v[176:177], v245 offset:49280
    ds_read_b64_tr_b16 v[178:179], v245 offset:50816
    ds_read_b64_tr_b16 v[180:181], v245 offset:52224
    ds_read_b64_tr_b16 v[182:183], v245 offset:53760
    ds_read_b64_tr_b16 v[184:185], v245 offset:52288
    ds_read_b64_tr_b16 v[186:187], v245 offset:53824
    ds_read_b64_tr_b16 v[188:189], v245 offset:52352
    ds_read_b64_tr_b16 v[190:191], v245 offset:53888
    v_pk_mul_f32 v[104:105], v[72:73], v[104:105]
    v_pk_mul_f32 v[106:107], v[74:75], v[106:107]
    v_pk_mul_f32 v[108:109], v[76:77], v[108:109]
    v_pk_mul_f32 v[110:111], v[78:79], v[110:111]
    v_pk_mul_f32 v[112:113], v[80:81], v[112:113]
    v_pk_mul_f32 v[114:115], v[82:83], v[114:115]
    v_pk_mul_f32 v[116:117], v[84:85], v[116:117]
    v_pk_mul_f32 v[118:119], v[86:87], v[118:119]
    v_pk_fma_f32 v[120:121], v[88:89], v[88:89], s[50:51] neg_lo:[1,0,0] neg_hi:[1,0,0]
    v_pk_fma_f32 v[122:123], v[90:91], v[90:91], s[50:51] neg_lo:[1,0,0] neg_hi:[1,0,0]
    v_pk_fma_f32 v[124:125], v[92:93], v[92:93], s[50:51] neg_lo:[1,0,0] neg_hi:[1,0,0]
    v_pk_fma_f32 v[126:127], v[94:95], v[94:95], s[50:51] neg_lo:[1,0,0] neg_hi:[1,0,0]
    v_pk_fma_f32 v[128:129], v[96:97], v[96:97], s[50:51] neg_lo:[1,0,0] neg_hi:[1,0,0]
    v_pk_fma_f32 v[130:131], v[98:99], v[98:99], s[50:51] neg_lo:[1,0,0] neg_hi:[1,0,0]
    v_pk_fma_f32 v[132:133], v[100:101], v[100:101], s[50:51] neg_lo:[1,0,0] neg_hi:[1,0,0]
    v_pk_fma_f32 v[134:135], v[102:103], v[102:103], s[50:51] neg_lo:[1,0,0] neg_hi:[1,0,0]
    v_pk_mul_f32 v[120:121], v[88:89], v[120:121]
    v_pk_mul_f32 v[122:123], v[90:91], v[122:123]
    v_pk_mul_f32 v[124:125], v[92:93], v[124:125]
    v_pk_mul_f32 v[126:127], v[94:95], v[126:127]
    v_pk_mul_f32 v[128:129], v[96:97], v[128:129]
    v_pk_mul_f32 v[130:131], v[98:99], v[130:131]
    v_pk_mul_f32 v[132:133], v[100:101], v[132:133]
    v_pk_mul_f32 v[134:135], v[102:103], v[134:135]
    v_cvt_pk_bf16_f32 v136, v104, v105
    v_cvt_pk_bf16_f32 v137, v106, v107
    v_cvt_pk_bf16_f32 v138, v108, v109
    v_cvt_pk_bf16_f32 v139, v110, v111
    v_cvt_pk_bf16_f32 v140, v112, v113
    v_cvt_pk_bf16_f32 v141, v114, v115
    v_cvt_pk_bf16_f32 v142, v116, v117
    v_cvt_pk_bf16_f32 v143, v118, v119
    v_exp_f32 v120, v120
    v_exp_f32 v121, v121
    v_exp_f32 v122, v122
    v_exp_f32 v123, v123
    s_waitcnt lgkmcnt(0)
    v_mfma_f32_32x32x16_bf16 v[0:15], v[168:171], v[136:139], v[0:15]
    v_exp_f32 v124, v124
    v_exp_f32 v125, v125
    v_exp_f32 v126, v126
    v_exp_f32 v127, v127
    v_mfma_f32_32x32x16_bf16 v[16:31], v[172:175], v[136:139], v[16:31]
    v_exp_f32 v128, v128
    v_exp_f32 v129, v129
    v_exp_f32 v130, v130
    v_exp_f32 v131, v131
    v_mfma_f32_32x32x16_bf16 v[32:47], v[176:179], v[136:139], v[32:47]
    v_exp_f32 v132, v132
    v_exp_f32 v133, v133
    v_exp_f32 v134, v134
    v_exp_f32 v135, v135
    v_pk_fma_f32 v[120:121], v[120:121], s[48:49], s[48:49]
    v_pk_fma_f32 v[122:123], v[122:123], s[48:49], s[48:49]
    v_pk_fma_f32 v[124:125], v[124:125], s[48:49], s[48:49]
    v_pk_fma_f32 v[126:127], v[126:127], s[48:49], s[48:49]
    v_pk_fma_f32 v[128:129], v[128:129], s[48:49], s[48:49]
    v_pk_fma_f32 v[130:131], v[130:131], s[48:49], s[48:49]
    v_pk_fma_f32 v[132:133], v[132:133], s[48:49], s[48:49]
    v_pk_fma_f32 v[134:135], v[134:135], s[48:49], s[48:49]
    v_mfma_f32_32x32x16_bf16 v[0:15], v[180:183], v[140:143], v[0:15]
    v_rcp_f32 v120, v120
    v_rcp_f32 v121, v121
    v_rcp_f32 v122, v122
    v_mfma_f32_32x32x16_bf16 v[16:31], v[184:187], v[140:143], v[16:31]
    v_rcp_f32 v123, v123
    v_rcp_f32 v124, v124
    v_rcp_f32 v125, v125
    v_mfma_f32_32x32x16_bf16 v[32:47], v[188:191], v[140:143], v[32:47]
    ds_read_b64_tr_b16 v[168:169], v245 offset:55296
    ds_read_b64_tr_b16 v[170:171], v245 offset:56832
    ds_read_b64_tr_b16 v[172:173], v245 offset:55360
    ds_read_b64_tr_b16 v[174:175], v245 offset:56896
    ds_read_b64_tr_b16 v[176:177], v245 offset:55424
    ds_read_b64_tr_b16 v[178:179], v245 offset:56960
    ds_read_b64_tr_b16 v[180:181], v245 offset:58368
    ds_read_b64_tr_b16 v[182:183], v245 offset:59904
    ds_read_b64_tr_b16 v[184:185], v245 offset:58432
    ds_read_b64_tr_b16 v[186:187], v245 offset:59968
    ds_read_b64_tr_b16 v[188:189], v245 offset:58496
    ds_read_b64_tr_b16 v[190:191], v245 offset:60032
    v_rcp_f32 v126, v126
    v_rcp_f32 v127, v127
    v_rcp_f32 v128, v128
    v_rcp_f32 v129, v129
    v_rcp_f32 v130, v130
    v_rcp_f32 v131, v131
    v_rcp_f32 v132, v132
    v_rcp_f32 v133, v133
    v_rcp_f32 v134, v134
    v_rcp_f32 v135, v135
    v_pk_mul_f32 v[120:121], v[88:89], v[120:121]
    v_pk_mul_f32 v[122:123], v[90:91], v[122:123]
    v_pk_mul_f32 v[124:125], v[92:93], v[124:125]
    v_pk_mul_f32 v[126:127], v[94:95], v[126:127]
    v_pk_mul_f32 v[128:129], v[96:97], v[128:129]
    v_pk_mul_f32 v[130:131], v[98:99], v[130:131]
    v_pk_mul_f32 v[132:133], v[100:101], v[132:133]
    v_pk_mul_f32 v[134:135], v[102:103], v[134:135]
    v_cvt_pk_bf16_f32 v136, v120, v121
    v_cvt_pk_bf16_f32 v137, v122, v123
    v_cvt_pk_bf16_f32 v138, v124, v125
    v_cvt_pk_bf16_f32 v139, v126, v127
    v_cvt_pk_bf16_f32 v140, v128, v129
    v_cvt_pk_bf16_f32 v141, v130, v131
    v_cvt_pk_bf16_f32 v142, v132, v133
    v_cvt_pk_bf16_f32 v143, v134, v135
    s_waitcnt lgkmcnt(0)
    v_mfma_f32_32x32x16_bf16 v[0:15], v[168:171], v[136:139], v[0:15]
    v_mfma_f32_32x32x16_bf16 v[0:15], v[180:183], v[140:143], v[0:15]
    v_mfma_f32_32x32x16_bf16 v[16:31], v[172:175], v[136:139], v[16:31]
    v_mfma_f32_32x32x16_bf16 v[16:31], v[184:187], v[140:143], v[16:31]
    v_mfma_f32_32x32x16_bf16 v[32:47], v[176:179], v[136:139], v[32:47]
    v_mfma_f32_32x32x16_bf16 v[32:47], v[188:191], v[140:143], v[32:47]
    s_nop 7
    v_cvt_pk_bf16_f32 v72, v0, v1
    v_cvt_pk_bf16_f32 v73, v2, v3
    v_cvt_pk_bf16_f32 v74, v4, v5
    v_cvt_pk_bf16_f32 v75, v6, v7
    v_cvt_pk_bf16_f32 v76, v8, v9
    v_cvt_pk_bf16_f32 v77, v10, v11
    v_cvt_pk_bf16_f32 v78, v12, v13
    v_cvt_pk_bf16_f32 v79, v14, v15
    ds_write_b128 v246, v[72:75] offset:0
    ds_write_b128 v247, v[76:79] offset:0
    v_cvt_pk_bf16_f32 v80, v16, v17
    v_cvt_pk_bf16_f32 v81, v18, v19
    v_cvt_pk_bf16_f32 v82, v20, v21
    v_cvt_pk_bf16_f32 v83, v22, v23
    v_cvt_pk_bf16_f32 v84, v24, v25
    v_cvt_pk_bf16_f32 v85, v26, v27
    v_cvt_pk_bf16_f32 v86, v28, v29
    v_cvt_pk_bf16_f32 v87, v30, v31
    ds_write_b128 v246, v[80:83] offset:64
    ds_write_b128 v247, v[84:87] offset:64
    v_cvt_pk_bf16_f32 v88, v32, v33
    v_cvt_pk_bf16_f32 v89, v34, v35
    v_cvt_pk_bf16_f32 v90, v36, v37
    v_cvt_pk_bf16_f32 v91, v38, v39
    v_cvt_pk_bf16_f32 v92, v40, v41
    v_cvt_pk_bf16_f32 v93, v42, v43
    v_cvt_pk_bf16_f32 v94, v44, v45
    v_cvt_pk_bf16_f32 v95, v46, v47
    ds_write_b128 v246, v[88:91] offset:128
    ds_write_b128 v247, v[92:95] offset:128
    ds_read_b128 v[104:107], v240 offset:0
    ds_read_b128 v[108:111], v241 offset:0
    ds_read_b128 v[112:115], v242 offset:0
    ds_read_b128 v[116:119], v240 offset:3072
    ds_read_b128 v[120:123], v241 offset:3072
    ds_read_b128 v[124:127], v242 offset:3072
    s_waitcnt lgkmcnt(5)
    buffer_store_dwordx4 v[104:107], v244, s[36:39], s60 offen offset:0 sc1
    s_waitcnt lgkmcnt(4)
    buffer_store_dwordx4 v[108:111], v244, s[36:39], s60 offen offset:1024 sc1
    s_waitcnt lgkmcnt(3)
    buffer_store_dwordx4 v[112:115], v244, s[36:39], s60 offen offset:2048 sc1
    s_waitcnt lgkmcnt(2)
    buffer_store_dwordx4 v[116:119], v244, s[36:39], s61 offen offset:0 sc1
    s_waitcnt lgkmcnt(1)
    buffer_store_dwordx4 v[120:123], v244, s[36:39], s61 offen offset:1024 sc1
    s_waitcnt lgkmcnt(0)
    buffer_store_dwordx4 v[124:127], v244, s[36:39], s61 offen offset:2048 sc1
    s_endpgm
L_slow1:
    ds_read_b32 v249, v243 offset:0
    s_waitcnt lgkmcnt(0)
    v_cmp_gt_u32 vcc, 2, v249
    s_cbranch_vccnz L_slow1
    s_branch L_back1
L_slow2:
    ds_read_b32 v249, v243 offset:0
    s_waitcnt lgkmcnt(0)
    v_cmp_gt_u32 vcc, 3, v249
    s_cbranch_vccnz L_slow2
    s_branch L_back2
L_slow3:
    ds_read_b32 v249, v243 offset:16
    s_waitcnt lgkmcnt(0)
    v_cmp_gt_u32 vcc, 6, v249
    s_cbranch_vccnz L_slow3
    s_branch L_back3
L_slow4:
    ds_read_b32 v249, v243 offset:16
    s_waitcnt lgkmcnt(0)
    v_cmp_gt_u32 vcc, 7, v249
    s_cbranch_vccnz L_slow4
    s_branch L_back4
L_slow5:
    ds_read_b32 v249, v243 offset:16
    s_waitcnt lgkmcnt(0)
    v_cmp_gt_u32 vcc, 8, v249
    s_cbranch_vccnz L_slow5
    s_branch L_back5
L_slow6:
    ds_read_b32 v249, v243 offset:0
    s_waitcnt lgkmcnt(0)
    v_cmp_gt_u32 vcc, 4, v249
    s_cbranch_vccnz L_slow6
    s_branch L_back6
L_L:
    s_mov_b32 exec_hi, -1
    v_lshlrev_b32 v244, 4, v255
    s_mul_i32 s57, s3, 3072
    s_add_u32 s57, s57, 147456
    s_mov_b32 s62, 147456
    s_add_u32 s47, s47, 815584
    s_lshr_b32 s47, s47, 16
    s_sub_u32 s47, s47, s41
    v_mov_b64 v[0:1], 0
    v_mov_b64 v[2:3], 0
    v_mov_b64 v[4:5], 0
    v_mov_b64 v[6:7], 0
    v_mov_b64 v[8:9], 0
    v_mov_b64 v[10:11], 0
    v_mov_b64 v[12:13], 0
    v_mov_b64 v[14:15], 0
    v_mov_b64 v[16:17], 0
    v_mov_b64 v[18:19], 0
    v_mov_b64 v[20:21], 0
    v_mov_b64 v[22:23], 0
    v_mov_b64 v[24:25], 0
    v_mov_b64 v[26:27], 0
    v_mov_b64 v[28:29], 0
    v_mov_b64 v[30:31], 0
    v_mov_b64 v[32:33], 0
    v_mov_b64 v[34:35], 0
    v_mov_b64 v[36:37], 0
    v_mov_b64 v[38:39], 0
    v_mov_b64 v[40:41], 0
    v_mov_b64 v[42:43], 0
    v_mov_b64 v[44:45], 0
    v_mov_b64 v[46:47], 0
    s_lshl_b32 s43, s40, 2
    s_add_u32 s43, s43, 163584
    v_mov_b32 v248, s43
    ds_write_b32 v248, v0
    s_mul_i32 s58, s3, 18432
    s_mul_i32 s59, s3, 3072
    s_mov_b64 s[28:29], s[10:11]
    s_mov_b32 s30, 73728
    s_mov_b32 s31, 0x00020000
    s_mov_b64 s[32:33], s[12:13]
    s_mov_b32 s34, 73728
    s_mov_b32 s35, 0x00020000
    s_mov_b64 s[36:37], s[14:15]
    s_mov_b32 s38, 9633792
    s_mov_b32 s39, 0x00020000
    s_mov_b32 s48, 0x3eeff558
    s_mov_b32 s49, 0x3eeff558
    s_mov_b32 s50, 0xc09d30fc
    s_mov_b32 s51, 0xc09d30fc
    s_add_u32 s43, s3, s41
    s_mul_i32 s43, s43, 224
    s_add_u32 s43, s43, s42
    s_mul_i32 s60, s43, 192
    s_waitcnt vmcnt(6)
    s_barrier
    ds_read_b128 v[196:199], v244 offset:1024
    ds_read_b128 v[192:195], v244 offset:0
    ds_read_b128 v[240:243], v244 offset:2048
    ds_read_b128 v[220:223], v244 offset:7168
    ds_read_b128 v[52:55], v244 offset:8192
    ds_read_b128 v[56:59], v244 offset:9216
    s_waitcnt lgkmcnt(4)
    s_lshl_b32 s43, s3, 4
    v_add_u32 v196, s43, v196
    v_add_u32 v197, s43, v197
    v_xor_b32 v192, s43, v192
    v_xor_b32 v193, s43, v193
    v_xor_b32 v194, s43, v194
    v_xor_b32 v195, s43, v195
    v_add_u32 v195, s62, v195
    ds_read_b64_tr_b16 v[86:87], v196 offset:0
    ds_read_b64_tr_b16 v[90:91], v196 offset:1952
    ds_read_b64_tr_b16 v[94:95], v196 offset:3904
    ds_read_b64_tr_b16 v[98:99], v197 offset:1952
    ds_read_b64_tr_b16 v[102:103], v197 offset:0
    ds_read_b64_tr_b16 v[106:107], v196 offset:64
    ds_read_b64_tr_b16 v[110:111], v196 offset:2016
    ds_read_b64_tr_b16 v[114:115], v196 offset:3968
    ds_read_b64_tr_b16 v[118:119], v197 offset:2016
    ds_read_b64_tr_b16 v[122:123], v197 offset:64
    ds_read_b64_tr_b16 v[126:127], v196 offset:128
    ds_read_b64_tr_b16 v[130:131], v196 offset:2080
    ds_read_b64_tr_b16 v[134:135], v196 offset:4032
    ds_read_b64_tr_b16 v[138:139], v197 offset:2080
    ds_read_b64_tr_b16 v[142:143], v197 offset:128
    s_waitcnt vmcnt(4)
    s_barrier
    s_waitcnt lgkmcnt(0)
    v_add_u32 v240, s57, v240
    v_add_u32 v241, s57, v241
    v_add_u32 v242, s57, v242
    s_and_b32 s44, s3, 1
    s_lshl_b32 s43, s44, 5
    v_xor_b32 v220, s43, v220
    v_xor_b32 v224, 32, v220
    s_add_u32 s60, s60, 344064
    s_lshl_b32 s43, s44, 6
    v_xor_b32 v52, s43, v52
    s_lshr_b32 s45, s3, 1
    s_mul_i32 s45, s45, 24576
    s_sub_u32 s46, 24576, s45
    v_add_u32 v204, s45, v52
    v_add_u32 v208, s46, v52
    v_xor_b32 v205, 32, v204
    v_xor_b32 v206, 64, v204
    v_xor_b32 v207, 0x60, v204
    v_xor_b32 v209, 32, v208
    v_xor_b32 v210, 64, v208
    v_xor_b32 v211, 0x60, v208
    s_mul_i32 s44, s44, 6144
    s_add_u32 s45, s45, 12288
    s_add_u32 s46, s46, 12288
    s_add_u32 s43, s45, s44
    v_add_u32 v212, s43, v53
    s_add_u32 s43, s46, s44
    v_add_u32 v216, s43, v53
    s_sub_u32 s44, 6144, s44
    s_add_u32 s43, s45, s44
    v_add_u32 v214, s43, v53
    s_add_u32 s43, s46, s44
    v_add_u32 v218, s43, v53
    v_xor_b32 v213, 32, v212
    v_xor_b32 v215, 32, v214
    v_xor_b32 v217, 32, v216
    v_xor_b32 v219, 32, v218
    v_add_u32 v225, 159744, v54
    v_add_u32 v50, 159744, v55
    v_xor_b32 v51, 8, v50
    v_add_u32 v48, s57, v55
    v_xor_b32 v49, 8, v48
    v_add_u32 v246, s57, v56
    v_xor_b32 v247, 32, v246
    s_mul_i32 s43, s3, 3840
    s_add_u32 s43, s43, 74112
    v_add_u32 v200, s43, v57
    v_xor_b32 v201, 32, v200
    s_waitcnt vmcnt(0)
    s_barrier
    s_and_b32 s43, s3, 1
    s_cselect_b64 s[44:45], s[12:13], s[10:11]
    s_lshr_b32 s43, s2, 3
    s_lshl_b32 s43, s43, 1
    s_lshr_b32 s46, s3, 1
    s_add_u32 s43, s43, s46
    s_mul_i32 s43, s43, 1280
    v_lshl_add_u32 v250, v255, 7, s43
    v_min_u32 v250, 73600, v250
    s_mov_b64 exec, 0x3ff
    global_load_dword v226, v250, s[44:45]
    s_mov_b64 exec, -1
    v_and_b32 v84, v198, v86
    v_bfi_b32 v85, v198, 0, v86
    v_and_b32 v86, v198, v87
    v_bfi_b32 v87, v198, 0, v87
    v_and_b32 v88, v198, v90
    v_bfi_b32 v89, v198, 0, v90
    v_and_b32 v90, v198, v91
    v_bfi_b32 v91, v198, 0, v91
    v_and_b32 v92, v198, v94
    v_bfi_b32 v93, v198, 0, v94
    v_and_b32 v94, v198, v95
    v_bfi_b32 v95, v198, 0, v95
    v_and_b32 v96, v198, v98
    v_bfi_b32 v97, v198, 0, v98
    v_and_b32 v98, v198, v99
    v_bfi_b32 v99, v198, 0, v99
    v_and_b32 v100, v198, v102
    v_bfi_b32 v101, v198, 0, v102
    v_and_b32 v102, v198, v103
    v_bfi_b32 v103, v198, 0, v103
    v_and_b32 v104, v198, v106
    v_bfi_b32 v105, v198, 0, v106
    v_and_b32 v106, v198, v107
    v_bfi_b32 v107, v198, 0, v107
    v_and_b32 v108, v198, v110
    v_bfi_b32 v109, v198, 0, v110
    v_and_b32 v110, v198, v111
    v_bfi_b32 v111, v198, 0, v111
    v_and_b32 v112, v198, v114
    v_bfi_b32 v113, v198, 0, v114
    v_and_b32 v114, v198, v115
    v_bfi_b32 v115, v198, 0, v115
    v_and_b32 v116, v198, v118
    v_bfi_b32 v117, v198, 0, v118
    v_and_b32 v118, v198, v119
    v_bfi_b32 v119, v198, 0, v119
    v_and_b32 v120, v198, v122
    v_bfi_b32 v121, v198, 0, v122
    v_and_b32 v122, v198, v123
    v_bfi_b32 v123, v198, 0, v123
    v_and_b32 v124, v198, v126
    v_bfi_b32 v125, v198, 0, v126
    v_and_b32 v126, v198, v127
    v_bfi_b32 v127, v198, 0, v127
    v_and_b32 v128, v198, v130
    v_bfi_b32 v129, v198, 0, v130
    v_and_b32 v130, v198, v131
    v_bfi_b32 v131, v198, 0, v131
    v_and_b32 v132, v198, v134
    v_bfi_b32 v133, v198, 0, v134
    v_and_b32 v134, v198, v135
    v_bfi_b32 v135, v198, 0, v135
    v_and_b32 v136, v198, v138
    v_bfi_b32 v137, v198, 0, v138
    v_and_b32 v138, v198, v139
    v_bfi_b32 v139, v198, 0, v139
    v_and_b32 v140, v198, v142
    v_bfi_b32 v141, v198, 0, v142
    v_and_b32 v142, v198, v143
    v_bfi_b32 v143, v198, 0, v143
    v_mov_b64 v[180:181], 0
    v_mov_b64 v[182:183], 0
    s_waitcnt lgkmcnt(0)
    s_barrier
    s_setprio 2
    s_cmp_lg_u32 s47, 13
    s_cbranch_scc1 L_L12
    ds_read_b128 v[144:147], v192 offset:30720
    ds_read_b128 v[148:151], v192 offset:34560
    ds_read_b128 v[152:155], v192 offset:38400
    ds_read_b128 v[156:159], v192 offset:42240
    ds_read_b128 v[160:163], v192 offset:46080
    ds_read_b128 v[164:167], v192 offset:49920
    ds_read_b128 v[168:171], v192 offset:53760
    ds_read_b128 v[172:175], v192 offset:57600
    ds_read_b128 v[60:63], v193 offset:30720
    ds_read_b128 v[64:67], v193 offset:46080
    s_waitcnt lgkmcnt(8)
    v_smfmac_f32_16x16x64_bf16 v[0:3], v[84:87], v[144:151], v199
    ds_read_b128 v[176:179], v192 offset:61440
    s_waitcnt lgkmcnt(7)
    v_smfmac_f32_16x16x64_bf16 v[0:3], v[88:91], v[152:159], v199
    ds_read_b128 v[68:71], v194 offset:61440
    v_smfmac_f32_16x16x64_bf16 v[4:7], v[84:87], v[152:159], v199
    s_waitcnt lgkmcnt(6)
    v_smfmac_f32_16x16x64_bf16 v[0:3], v[92:95], v[160:167], v199
    ds_read_b128 v[184:187], v192 offset:30784
    v_smfmac_f32_16x16x64_bf16 v[4:7], v[88:91], v[160:167], v199
    ds_read_b128 v[188:191], v192 offset:34624
    v_smfmac_f32_16x16x64_bf16 v[8:11], v[84:87], v[160:167], v199
    s_waitcnt lgkmcnt(6)
    v_smfmac_f32_16x16x64_bf16 v[4:7], v[92:95], v[168:175], v199
    ds_read_b128 v[144:147], v192 offset:38464
    v_smfmac_f32_16x16x64_bf16 v[8:11], v[88:91], v[168:175], v199
    ds_read_b128 v[148:151], v192 offset:42304
    s_waitcnt lgkmcnt(6)
    v_smfmac_f32_16x16x64_bf16 v[0:3], v[96:99], v[60:67], v199
    ds_read_b128 v[152:155], v192 offset:46144
    v_smfmac_f32_16x16x64_bf16 v[4:7], v[100:103], v[60:67], v199
    ds_read_b128 v[156:159], v192 offset:49984
    s_waitcnt lgkmcnt(7)
    v_smfmac_f32_16x16x64_bf16 v[8:11], v[92:95], v[176:183], v199
    ds_read_b128 v[160:163], v192 offset:53824
    ds_read_b128 v[164:167], v192 offset:57664
    s_waitcnt lgkmcnt(8)
    v_smfmac_f32_16x16x64_bf16 v[8:11], v[96:99], v[64:71], v199
    ds_read_b128 v[72:75], v193 offset:30784
    ds_read_b128 v[76:79], v193 offset:46144
    s_waitcnt lgkmcnt(8)
    v_smfmac_f32_16x16x64_bf16 v[16:19], v[104:107], v[184:191], v199
    ds_read_b128 v[168:171], v192 offset:61504
    v_cvt_pk_bf16_f32 v0, v0, v1
    v_cvt_pk_bf16_f32 v1, v2, v3
    v_cvt_pk_bf16_f32 v4, v4, v5
    v_cvt_pk_bf16_f32 v5, v6, v7
    v_cvt_pk_bf16_f32 v8, v8, v9
    v_cvt_pk_bf16_f32 v9, v10, v11
    ds_write_b64 v195, v[0:1] offset:0
    ds_write_b64 v195, v[4:5] offset:6144
    s_mov_b32 exec_lo, 0xffff
    s_mov_b32 exec_hi, 0xffff
    ds_write_b64 v195, v[8:9] offset:12288
    s_mov_b64 exec, -1
    s_waitcnt lgkmcnt(10)
    v_smfmac_f32_16x16x64_bf16 v[16:19], v[108:111], v[144:151], v199
    ds_read_b128 v[80:83], v194 offset:61504
    v_smfmac_f32_16x16x64_bf16 v[20:23], v[104:107], v[144:151], v199
    s_waitcnt lgkmcnt(9)
    v_smfmac_f32_16x16x64_bf16 v[16:19], v[112:115], v[152:159], v199
    ds_read_b128 v[176:179], v192 offset:30848
    v_smfmac_f32_16x16x64_bf16 v[20:23], v[108:111], v[152:159], v199
    ds_read_b128 v[180:183], v192 offset:34688
    v_smfmac_f32_16x16x64_bf16 v[24:27], v[104:107], v[152:159], v199
    s_waitcnt lgkmcnt(9)
    v_smfmac_f32_16x16x64_bf16 v[20:23], v[112:115], v[160:167], v199
    ds_read_b128 v[184:187], v192 offset:38528
    v_smfmac_f32_16x16x64_bf16 v[24:27], v[108:111], v[160:167], v199
    ds_read_b128 v[188:191], v192 offset:42368
    s_waitcnt lgkmcnt(9)
    v_smfmac_f32_16x16x64_bf16 v[16:19], v[116:119], v[72:79], v199
    ds_read_b128 v[144:147], v192 offset:46208
    v_smfmac_f32_16x16x64_bf16 v[20:23], v[120:123], v[72:79], v199
    ds_read_b128 v[148:151], v192 offset:50048
    s_waitcnt lgkmcnt(10)
    v_smfmac_f32_16x16x64_bf16 v[24:27], v[112:115], v[168:175], v199
    ds_read_b128 v[152:155], v192 offset:53888
    ds_read_b128 v[156:159], v192 offset:57728
    s_waitcnt lgkmcnt(8)
    v_smfmac_f32_16x16x64_bf16 v[24:27], v[116:119], v[76:83], v199
    ds_read_b128 v[228:231], v193 offset:30848
    ds_read_b128 v[232:235], v193 offset:46208
    s_waitcnt lgkmcnt(8)
    v_smfmac_f32_16x16x64_bf16 v[32:35], v[124:127], v[176:183], v199
    ds_read_b128 v[160:163], v192 offset:61568
    v_cvt_pk_bf16_f32 v16, v16, v17
    v_cvt_pk_bf16_f32 v17, v18, v19
    v_cvt_pk_bf16_f32 v20, v20, v21
    v_cvt_pk_bf16_f32 v21, v22, v23
    v_cvt_pk_bf16_f32 v24, v24, v25
    v_cvt_pk_bf16_f32 v25, v26, v27
    ds_write_b64 v195, v[16:17] offset:64
    ds_write_b64 v195, v[20:21] offset:6208
    s_mov_b32 exec_lo, 0xffff
    s_mov_b32 exec_hi, 0xffff
    ds_write_b64 v195, v[24:25] offset:12352
    s_mov_b64 exec, -1
    s_waitcnt lgkmcnt(10)
    v_smfmac_f32_16x16x64_bf16 v[32:35], v[128:131], v[184:191], v199
    ds_read_b128 v[236:239], v194 offset:61568
    v_smfmac_f32_16x16x64_bf16 v[36:39], v[124:127], v[184:191], v199
    s_waitcnt lgkmcnt(9)
    v_smfmac_f32_16x16x64_bf16 v[32:35], v[132:135], v[144:151], v199
    v_smfmac_f32_16x16x64_bf16 v[36:39], v[128:131], v[144:151], v199
    v_smfmac_f32_16x16x64_bf16 v[40:43], v[124:127], v[144:151], v199
    s_waitcnt lgkmcnt(7)
    v_smfmac_f32_16x16x64_bf16 v[36:39], v[132:135], v[152:159], v199
    v_smfmac_f32_16x16x64_bf16 v[40:43], v[128:131], v[152:159], v199
    s_waitcnt lgkmcnt(5)
    v_smfmac_f32_16x16x64_bf16 v[32:35], v[136:139], v[228:235], v199
    v_smfmac_f32_16x16x64_bf16 v[36:39], v[140:143], v[228:235], v199
    s_waitcnt lgkmcnt(4)
    v_smfmac_f32_16x16x64_bf16 v[40:43], v[132:135], v[160:167], v199
    s_waitcnt lgkmcnt(0)
    v_smfmac_f32_16x16x64_bf16 v[40:43], v[136:139], v[232:239], v199
    s_nop 2
    v_cvt_pk_bf16_f32 v32, v32, v33
    v_cvt_pk_bf16_f32 v33, v34, v35
    v_cvt_pk_bf16_f32 v36, v36, v37
    v_cvt_pk_bf16_f32 v37, v38, v39
    s_nop 0
    v_cvt_pk_bf16_f32 v40, v40, v41
    v_cvt_pk_bf16_f32 v41, v42, v43
    ds_write_b64 v195, v[32:33] offset:128
    ds_write_b64 v195, v[36:37] offset:6272
    s_mov_b32 exec_lo, 0xffff
    s_mov_b32 exec_hi, 0xffff
    ds_write_b64 v195, v[40:41] offset:12416
    s_mov_b64 exec, -1
    v_mov_b32 v254, 2
    ds_write_b32 v248, v254
    ds_read_b64 v[60:61], v200 offset:38400
    ds_read_b64 v[62:63], v201 offset:38400
    ds_read_b64 v[64:65], v200 offset:38464
    ds_read_b64 v[66:67], v201 offset:38464
    ds_read_b64 v[68:69], v200 offset:38528
    ds_read_b64 v[70:71], v201 offset:38528
    ds_read_b64 v[72:73], v200 offset:49920
    ds_read_b64 v[74:75], v201 offset:49920
    ds_read_b64 v[76:77], v200 offset:49984
    ds_read_b64 v[78:79], v201 offset:49984
    ds_read_b64 v[80:81], v200 offset:50048
    ds_read_b64 v[82:83], v201 offset:50048
L_poll7:
    ds_read_b32 v249, v243 offset:16
    s_waitcnt lgkmcnt(0)
    v_cmp_gt_u32 vcc, 2, v249
    s_cbranch_vccnz L_poll7
    ds_read_b64 v[168:169], v48 offset:0
    ds_read_b64 v[170:171], v49 offset:0
    ds_read_b64 v[172:173], v48 offset:64
    ds_read_b64 v[174:175], v49 offset:64
    ds_read_b64 v[176:177], v48 offset:128
    ds_read_b64 v[178:179], v49 offset:128
    v_lshlrev_b32 v0, 16, v60
    v_and_b32 v1, 0xffff0000, v60
    v_lshlrev_b32 v2, 16, v61
    v_and_b32 v3, 0xffff0000, v61
    v_lshlrev_b32 v4, 16, v62
    v_and_b32 v5, 0xffff0000, v62
    v_lshlrev_b32 v6, 16, v63
    v_and_b32 v7, 0xffff0000, v63
    v_lshlrev_b32 v8, 16, v64
    v_and_b32 v9, 0xffff0000, v64
    v_lshlrev_b32 v10, 16, v65
    v_and_b32 v11, 0xffff0000, v65
    v_lshlrev_b32 v12, 16, v66
    v_and_b32 v13, 0xffff0000, v66
    v_lshlrev_b32 v14, 16, v67
    v_and_b32 v15, 0xffff0000, v67
    v_lshlrev_b32 v16, 16, v68
    v_and_b32 v17, 0xffff0000, v68
    v_lshlrev_b32 v18, 16, v69
    v_and_b32 v19, 0xffff0000, v69
    v_lshlrev_b32 v20, 16, v70
    v_and_b32 v21, 0xffff0000, v70
    v_lshlrev_b32 v22, 16, v71
    v_and_b32 v23, 0xffff0000, v71
    s_cmp_eq_u32 s3, 1
    s_cbranch_scc1 L_ria
    v_mov_b64 v[24:25], 0
    v_mov_b64 v[26:27], 0
    v_mov_b64 v[28:29], 0
    v_mov_b64 v[30:31], 0
    v_mov_b64 v[32:33], 0
    v_mov_b64 v[34:35], 0
    v_mov_b64 v[36:37], 0
    v_mov_b64 v[38:39], 0
    v_mov_b64 v[40:41], 0
    v_mov_b64 v[42:43], 0
    v_mov_b64 v[44:45], 0
    v_mov_b64 v[46:47], 0
    s_branch L_rja
L_ria:
    v_lshlrev_b32 v24, 16, v72
    v_and_b32 v25, 0xffff0000, v72
    v_lshlrev_b32 v26, 16, v73
    v_and_b32 v27, 0xffff0000, v73
    v_lshlrev_b32 v28, 16, v74
    v_and_b32 v29, 0xffff0000, v74
    v_lshlrev_b32 v30, 16, v75
    v_and_b32 v31, 0xffff0000, v75
    v_lshlrev_b32 v32, 16, v76
    v_and_b32 v33, 0xffff0000, v76
    v_lshlrev_b32 v34, 16, v77
    v_and_b32 v35, 0xffff0000, v77
    v_lshlrev_b32 v36, 16, v78
    v_and_b32 v37, 0xffff0000, v78
    v_lshlrev_b32 v38, 16, v79
    v_and_b32 v39, 0xffff0000, v79
    v_lshlrev_b32 v40, 16, v80
    v_and_b32 v41, 0xffff0000, v80
    v_lshlrev_b32 v42, 16, v81
    v_and_b32 v43, 0xffff0000, v81
    v_lshlrev_b32 v44, 16, v82
    v_and_b32 v45, 0xffff0000, v82
    v_lshlrev_b32 v46, 16, v83
    v_and_b32 v47, 0xffff0000, v83
L_rja:
    v_mov_b32 v254, 3
    ds_write_b32 v248, v254
    ds_read_b64 v[180:181], v50 offset:0
    ds_read_b64 v[182:183], v51 offset:0
    ds_read_b64 v[184:185], v50 offset:64
    ds_read_b64 v[186:187], v51 offset:64
    ds_read_b64 v[188:189], v50 offset:128
    ds_read_b64 v[190:191], v51 offset:128
    s_waitcnt lgkmcnt(7)
    v_mov_b32 v254, 0x3f803f80
    v_lshlrev_b32 v72, 16, v168
    v_and_b32 v73, 0xffff0000, v168
    v_lshlrev_b32 v74, 16, v169
    v_and_b32 v75, 0xffff0000, v169
    v_lshlrev_b32 v76, 16, v170
    v_and_b32 v77, 0xffff0000, v170
    v_lshlrev_b32 v78, 16, v171
    v_and_b32 v79, 0xffff0000, v171
    v_lshlrev_b32 v80, 16, v172
    v_and_b32 v81, 0xffff0000, v172
    v_lshlrev_b32 v82, 16, v173
    v_and_b32 v83, 0xffff0000, v173
    v_lshlrev_b32 v84, 16, v174
    v_and_b32 v85, 0xffff0000, v174
    v_lshlrev_b32 v86, 16, v175
    v_and_b32 v87, 0xffff0000, v175
    v_dot2_f32_bf16 v251, v168, v254, 0
    v_dot2_f32_bf16 v253, v168, v168, 0
    v_dot2_f32_bf16 v251, v169, v254, v251
    v_dot2_f32_bf16 v253, v169, v169, v253
    v_dot2_f32_bf16 v251, v170, v254, v251
    v_dot2_f32_bf16 v253, v170, v170, v253
    v_dot2_f32_bf16 v251, v171, v254, v251
    v_dot2_f32_bf16 v253, v171, v171, v253
    v_dot2_f32_bf16 v251, v172, v254, v251
    v_dot2_f32_bf16 v253, v172, v172, v253
    v_dot2_f32_bf16 v251, v173, v254, v251
    v_dot2_f32_bf16 v253, v173, v173, v253
    v_dot2_f32_bf16 v251, v174, v254, v251
    v_dot2_f32_bf16 v253, v174, v174, v253
    v_dot2_f32_bf16 v251, v175, v254, v251
    v_dot2_f32_bf16 v253, v175, v175, v253
    v_dot2_f32_bf16 v251, v176, v254, v251
    v_dot2_f32_bf16 v253, v176, v176, v253
    v_dot2_f32_bf16 v251, v177, v254, v251
    v_dot2_f32_bf16 v253, v177, v177, v253
    v_dot2_f32_bf16 v251, v178, v254, v251
    v_dot2_f32_bf16 v253, v178, v178, v253
    v_dot2_f32_bf16 v251, v179, v254, v251
    v_dot2_f32_bf16 v253, v179, v179, v253
    v_lshlrev_b32 v88, 16, v176
    v_and_b32 v89, 0xffff0000, v176
    v_lshlrev_b32 v90, 16, v177
    v_permlane32_swap_b32 v251, v253
    v_add_f32 v251, v251, v253
    v_mov_b32 v253, v251
    v_and_b32 v91, 0xffff0000, v177
    v_lshlrev_b32 v92, 16, v178
    v_permlane16_swap_b32 v251, v253
    v_add_f32 v251, v251, v253
    v_mul_f32 v251, 0x3c2aaaab, v251
    v_mov_b32 v253, v251
    v_and_b32 v93, 0xffff0000, v178
    v_lshlrev_b32 v94, 16, v179
    v_permlane32_swap_b32 v251, v253
    v_fma_f32 v253, -v251, v251, v253
    v_max_f32 v253, 0, v253
    v_add_f32 v253, 0x3727c5ac, v253
    v_rsq_f32 v253, v253
    v_and_b32 v95, 0xffff0000, v179
    v_mul_f32 v250, 0x3eeff558, v253
    v_mul_f32 v252, -v251, v250
    ds_read_b32 v249, v243 offset:0
    v_pk_fma_f32 v[72:73], v[72:73], v[250:251], v[252:253] op_sel_hi:[1,0,0]
    v_pk_fma_f32 v[74:75], v[74:75], v[250:251], v[252:253] op_sel_hi:[1,0,0]
    v_pk_fma_f32 v[76:77], v[76:77], v[250:251], v[252:253] op_sel_hi:[1,0,0]
    v_pk_fma_f32 v[78:79], v[78:79], v[250:251], v[252:253] op_sel_hi:[1,0,0]
    v_pk_fma_f32 v[80:81], v[80:81], v[250:251], v[252:253] op_sel_hi:[1,0,0]
    v_pk_fma_f32 v[82:83], v[82:83], v[250:251], v[252:253] op_sel_hi:[1,0,0]
    v_pk_fma_f32 v[84:85], v[84:85], v[250:251], v[252:253] op_sel_hi:[1,0,0]
    v_pk_fma_f32 v[86:87], v[86:87], v[250:251], v[252:253] op_sel_hi:[1,0,0]
    v_pk_fma_f32 v[88:89], v[88:89], v[250:251], v[252:253] op_sel_hi:[1,0,0]
    v_pk_fma_f32 v[90:91], v[90:91], v[250:251], v[252:253] op_sel_hi:[1,0,0]
    v_pk_fma_f32 v[92:93], v[92:93], v[250:251], v[252:253] op_sel_hi:[1,0,0]
    v_pk_fma_f32 v[94:95], v[94:95], v[250:251], v[252:253] op_sel_hi:[1,0,0]
    s_waitcnt lgkmcnt(0)
    v_cmp_gt_u32 vcc, 2, v249
    s_cbranch_vccnz L_slow8
L_back8:
    ds_read_b64_tr_b16 v[144:145], v204 offset:0
    ds_read_b64_tr_b16 v[146:147], v204 offset:512
    ds_read_b64_tr_b16 v[148:149], v204 offset:4096
    ds_read_b64_tr_b16 v[150:151], v204 offset:4608
    ds_read_b64_tr_b16 v[152:153], v204 offset:8192
    ds_read_b64_tr_b16 v[154:155], v204 offset:8704
    ds_read_b64_tr_b16 v[156:157], v205 offset:0
    ds_read_b64_tr_b16 v[158:159], v205 offset:512
    ds_read_b64_tr_b16 v[160:161], v205 offset:4096
    ds_read_b64_tr_b16 v[162:163], v205 offset:4608
    ds_read_b64_tr_b16 v[164:165], v205 offset:8192
    ds_read_b64_tr_b16 v[166:167], v205 offset:8704
    v_cvt_pk_bf16_f32 v48, v72, v73
    v_cvt_pk_bf16_f32 v49, v74, v75
    v_cvt_pk_bf16_f32 v50, v76, v77
    v_cvt_pk_bf16_f32 v51, v78, v79
    v_cvt_pk_bf16_f32 v52, v80, v81
    v_cvt_pk_bf16_f32 v53, v82, v83
    v_cvt_pk_bf16_f32 v54, v84, v85
    v_cvt_pk_bf16_f32 v55, v86, v87
    v_cvt_pk_bf16_f32 v56, v88, v89
    v_cvt_pk_bf16_f32 v57, v90, v91
    v_cvt_pk_bf16_f32 v58, v92, v93
    v_cvt_pk_bf16_f32 v59, v94, v95
    s_cmp_lg_u32 s3, 3
    s_cbranch_scc1 L_nl12
    v_mov_b32 v254, 0x3f803f80
    v_lshlrev_b32 v72, 16, v180
    v_and_b32 v73, 0xffff0000, v180
    v_lshlrev_b32 v74, 16, v181
    v_and_b32 v75, 0xffff0000, v181
    v_lshlrev_b32 v76, 16, v182
    v_and_b32 v77, 0xffff0000, v182
    v_lshlrev_b32 v78, 16, v183
    v_and_b32 v79, 0xffff0000, v183
    v_lshlrev_b32 v80, 16, v184
    v_and_b32 v81, 0xffff0000, v184
    v_lshlrev_b32 v82, 16, v185
    v_and_b32 v83, 0xffff0000, v185
    v_lshlrev_b32 v84, 16, v186
    v_and_b32 v85, 0xffff0000, v186
    v_lshlrev_b32 v86, 16, v187
    v_and_b32 v87, 0xffff0000, v187
    v_dot2_f32_bf16 v251, v180, v254, 0
    v_dot2_f32_bf16 v253, v180, v180, 0
    v_dot2_f32_bf16 v251, v181, v254, v251
    v_dot2_f32_bf16 v253, v181, v181, v253
    v_dot2_f32_bf16 v251, v182, v254, v251
    v_dot2_f32_bf16 v253, v182, v182, v253
    v_dot2_f32_bf16 v251, v183, v254, v251
    v_dot2_f32_bf16 v253, v183, v183, v253
    v_dot2_f32_bf16 v251, v184, v254, v251
    v_dot2_f32_bf16 v253, v184, v184, v253
    v_dot2_f32_bf16 v251, v185, v254, v251
    v_dot2_f32_bf16 v253, v185, v185, v253
    v_dot2_f32_bf16 v251, v186, v254, v251
    v_dot2_f32_bf16 v253, v186, v186, v253
    v_dot2_f32_bf16 v251, v187, v254, v251
    v_dot2_f32_bf16 v253, v187, v187, v253
    v_dot2_f32_bf16 v251, v188, v254, v251
    v_dot2_f32_bf16 v253, v188, v188, v253
    v_dot2_f32_bf16 v251, v189, v254, v251
    v_dot2_f32_bf16 v253, v189, v189, v253
    v_dot2_f32_bf16 v251, v190, v254, v251
    v_dot2_f32_bf16 v253, v190, v190, v253
    v_dot2_f32_bf16 v251, v191, v254, v251
    v_dot2_f32_bf16 v253, v191, v191, v253
    v_lshlrev_b32 v88, 16, v188
    v_and_b32 v89, 0xffff0000, v188
    v_lshlrev_b32 v90, 16, v189
    v_permlane32_swap_b32 v251, v253
    v_add_f32 v251, v251, v253
    v_mov_b32 v253, v251
    v_and_b32 v91, 0xffff0000, v189
    v_lshlrev_b32 v92, 16, v190
    v_permlane16_swap_b32 v251, v253
    v_add_f32 v251, v251, v253
    v_mul_f32 v251, 0x3c2aaaab, v251
    v_mov_b32 v253, v251
    v_and_b32 v93, 0xffff0000, v190
    v_lshlrev_b32 v94, 16, v191
    v_permlane32_swap_b32 v251, v253
    v_fma_f32 v253, -v251, v251, v253
    v_max_f32 v253, 0, v253
    v_add_f32 v253, 0x3727c5ac, v253
    v_rsq_f32 v253, v253
    v_and_b32 v95, 0xffff0000, v191
    v_mul_f32 v250, 0x3eeff558, v253
    v_mul_f32 v252, -v251, v250
    v_pk_fma_f32 v[72:73], v[72:73], v[250:251], v[252:253] op_sel_hi:[1,0,0]
    v_pk_fma_f32 v[74:75], v[74:75], v[250:251], v[252:253] op_sel_hi:[1,0,0]
    v_pk_fma_f32 v[76:77], v[76:77], v[250:251], v[252:253] op_sel_hi:[1,0,0]
    v_pk_fma_f32 v[78:79], v[78:79], v[250:251], v[252:253] op_sel_hi:[1,0,0]
    v_pk_fma_f32 v[80:81], v[80:81], v[250:251], v[252:253] op_sel_hi:[1,0,0]
    v_pk_fma_f32 v[82:83], v[82:83], v[250:251], v[252:253] op_sel_hi:[1,0,0]
    v_pk_fma_f32 v[84:85], v[84:85], v[250:251], v[252:253] op_sel_hi:[1,0,0]
    v_pk_fma_f32 v[86:87], v[86:87], v[250:251], v[252:253] op_sel_hi:[1,0,0]
    v_pk_fma_f32 v[88:89], v[88:89], v[250:251], v[252:253] op_sel_hi:[1,0,0]
    v_pk_fma_f32 v[90:91], v[90:91], v[250:251], v[252:253] op_sel_hi:[1,0,0]
    v_pk_fma_f32 v[92:93], v[92:93], v[250:251], v[252:253] op_sel_hi:[1,0,0]
    v_pk_fma_f32 v[94:95], v[94:95], v[250:251], v[252:253] op_sel_hi:[1,0,0]
    v_cvt_pk_bf16_f32 v180, v72, v73
    v_cvt_pk_bf16_f32 v181, v74, v75
    v_cvt_pk_bf16_f32 v182, v76, v77
    v_cvt_pk_bf16_f32 v183, v78, v79
    v_cvt_pk_bf16_f32 v184, v80, v81
    v_cvt_pk_bf16_f32 v185, v82, v83
    v_cvt_pk_bf16_f32 v186, v84, v85
    v_cvt_pk_bf16_f32 v187, v86, v87
    v_cvt_pk_bf16_f32 v188, v88, v89
    v_cvt_pk_bf16_f32 v189, v90, v91
    v_cvt_pk_bf16_f32 v190, v92, v93
    v_cvt_pk_bf16_f32 v191, v94, v95
    ds_write_b128 v225, v[180:183] offset:0
    ds_write_b128 v225, v[184:187] offset:64
    ds_write_b128 v225, v[188:191] offset:128
L_nl12:
    v_mov_b32 v254, 5
    ds_write_b32 v248, v254
    s_waitcnt lgkmcnt(0)
    v_mfma_f32_16x16x32_bf16 v[72:75], v[144:147], v[48:51], 0
    v_mfma_f32_16x16x32_bf16 v[76:79], v[156:159], v[48:51], 0
    v_mfma_f32_16x16x32_bf16 v[72:75], v[148:151], v[52:55], v[72:75]
    v_mfma_f32_16x16x32_bf16 v[76:79], v[160:163], v[52:55], v[76:79]
    v_mfma_f32_16x16x32_bf16 v[72:75], v[152:155], v[56:59], v[72:75]
    v_mfma_f32_16x16x32_bf16 v[76:79], v[164:167], v[56:59], v[76:79]
    ds_read_b64_tr_b16 v[144:145], v206 offset:0
    ds_read_b64_tr_b16 v[146:147], v206 offset:512
    ds_read_b64_tr_b16 v[148:149], v206 offset:4096
    ds_read_b64_tr_b16 v[150:151], v206 offset:4608
    ds_read_b64_tr_b16 v[152:153], v206 offset:8192
    ds_read_b64_tr_b16 v[154:155], v206 offset:8704
    ds_read_b64_tr_b16 v[156:157], v207 offset:0
    ds_read_b64_tr_b16 v[158:159], v207 offset:512
    ds_read_b64_tr_b16 v[160:161], v207 offset:4096
    ds_read_b64_tr_b16 v[162:163], v207 offset:4608
    ds_read_b64_tr_b16 v[164:165], v207 offset:8192
    ds_read_b64_tr_b16 v[166:167], v207 offset:8704
    ds_read_b32 v249, v243 offset:16
    s_setprio 1
    v_pk_fma_f32 v[104:105], v[72:73], v[72:73], s[50:51] neg_lo:[1,0,0] neg_hi:[1,0,0]
    v_pk_fma_f32 v[106:107], v[74:75], v[74:75], s[50:51] neg_lo:[1,0,0] neg_hi:[1,0,0]
    v_pk_fma_f32 v[108:109], v[76:77], v[76:77], s[50:51] neg_lo:[1,0,0] neg_hi:[1,0,0]
    v_pk_fma_f32 v[110:111], v[78:79], v[78:79], s[50:51] neg_lo:[1,0,0] neg_hi:[1,0,0]
    v_pk_mul_f32 v[104:105], v[72:73], v[104:105]
    v_pk_mul_f32 v[106:107], v[74:75], v[106:107]
    v_pk_mul_f32 v[108:109], v[76:77], v[108:109]
    v_pk_mul_f32 v[110:111], v[78:79], v[110:111]
    s_waitcnt lgkmcnt(0)
    v_mfma_f32_16x16x32_bf16 v[88:91], v[144:147], v[48:51], 0
    v_exp_f32 v104, v104
    v_exp_f32 v105, v105
    v_mfma_f32_16x16x32_bf16 v[92:95], v[156:159], v[48:51], 0
    v_exp_f32 v106, v106
    v_exp_f32 v107, v107
    v_mfma_f32_16x16x32_bf16 v[88:91], v[148:151], v[52:55], v[88:91]
    v_exp_f32 v108, v108
    v_mfma_f32_16x16x32_bf16 v[92:95], v[160:163], v[52:55], v[92:95]
    v_exp_f32 v109, v109
    v_mfma_f32_16x16x32_bf16 v[88:91], v[152:155], v[56:59], v[88:91]
    v_exp_f32 v110, v110
    v_mfma_f32_16x16x32_bf16 v[92:95], v[164:167], v[56:59], v[92:95]
    s_waitcnt lgkmcnt(0)
    v_exp_f32 v111, v111
    v_cmp_gt_u32 vcc, 3, v249
    s_cbranch_vccnz L_slow9
L_back9:
    s_setprio 0
    ds_read_b64_tr_b16 v[144:145], v208 offset:0
    ds_read_b64_tr_b16 v[146:147], v208 offset:512
    ds_read_b64_tr_b16 v[148:149], v208 offset:4096
    ds_read_b64_tr_b16 v[150:151], v208 offset:4608
    ds_read_b64_tr_b16 v[152:153], v208 offset:8192
    ds_read_b64_tr_b16 v[154:155], v208 offset:8704
    ds_read_b64_tr_b16 v[156:157], v209 offset:0
    ds_read_b64_tr_b16 v[158:159], v209 offset:512
    ds_read_b64_tr_b16 v[160:161], v209 offset:4096
    ds_read_b64_tr_b16 v[162:163], v209 offset:4608
    ds_read_b64_tr_b16 v[164:165], v209 offset:8192
    ds_read_b64_tr_b16 v[166:167], v209 offset:8704
    s_add_u32 m0, s59, 49152
    s_add_u32 s43, s58, 256
    buffer_load_dwordx4 v220, s[28:31], s43 offen lds
    s_add_u32 m0, s59, 50176
    s_add_u32 s43, s58, 6400
    buffer_load_dwordx4 v224, s[28:31], s43 offen lds
    s_add_u32 m0, s59, 51200
    s_add_u32 s43, s58, 12544
    buffer_load_dwordx4 v220, s[28:31], s43 offen lds
    s_add_u32 m0, s59, 73728
    s_add_u32 s43, s58, 384
    buffer_load_dwordx4 v220, s[28:31], s43 offen lds
    s_add_u32 m0, s59, 74752
    s_add_u32 s43, s58, 6528
    buffer_load_dwordx4 v224, s[28:31], s43 offen lds
    s_add_u32 m0, s59, 75776
    s_add_u32 s43, s58, 12672
    buffer_load_dwordx4 v220, s[28:31], s43 offen lds
    ds_read_b32 v249, v243 offset:0
    s_setprio 1
    v_pk_fma_f32 v[104:105], v[104:105], s[48:49], s[48:49]
    v_pk_fma_f32 v[106:107], v[106:107], s[48:49], s[48:49]
    v_pk_fma_f32 v[108:109], v[108:109], s[48:49], s[48:49]
    v_pk_fma_f32 v[110:111], v[110:111], s[48:49], s[48:49]
    v_rcp_f32 v104, v104
    v_rcp_f32 v105, v105
    v_rcp_f32 v106, v106
    v_rcp_f32 v107, v107
    v_rcp_f32 v108, v108
    v_rcp_f32 v109, v109
    v_rcp_f32 v110, v110
    v_rcp_f32 v111, v111
    s_waitcnt lgkmcnt(0)
    v_cmp_gt_u32 vcc, 3, v249
    s_cbranch_vccnz L_slow10
L_back10:
    s_setprio 0
    ds_read_b64_tr_b16 v[168:169], v212 offset:0
    ds_read_b64_tr_b16 v[170:171], v212 offset:3072
    ds_read_b64_tr_b16 v[172:173], v213 offset:0
    ds_read_b64_tr_b16 v[174:175], v213 offset:3072
    ds_read_b64_tr_b16 v[176:177], v212 offset:64
    ds_read_b64_tr_b16 v[178:179], v212 offset:3136
    ds_read_b64_tr_b16 v[180:181], v213 offset:64
    ds_read_b64_tr_b16 v[182:183], v213 offset:3136
    ds_read_b64_tr_b16 v[184:185], v212 offset:128
    ds_read_b64_tr_b16 v[186:187], v212 offset:3200
    ds_read_b64_tr_b16 v[188:189], v213 offset:128
    ds_read_b64_tr_b16 v[190:191], v213 offset:3200
    s_add_u32 m0, s59, 61440
    s_add_u32 s43, s59, 24576
    buffer_load_dwordx4 v221, s[32:35], s43 offen offset:0 lds
    buffer_load_dwordx4 v222, s[32:35], s43 offen offset:1024 lds
    buffer_load_dwordx4 v223, s[32:35], s43 offen offset:2048 lds
    ds_read_b32 v249, v243 offset:16
    s_setprio 1
    v_pk_mul_f32 v[104:105], v[72:73], v[104:105]
    v_pk_mul_f32 v[106:107], v[74:75], v[106:107]
    v_pk_mul_f32 v[108:109], v[76:77], v[108:109]
    v_pk_mul_f32 v[110:111], v[78:79], v[110:111]
    v_pk_fma_f32 v[120:121], v[88:89], v[88:89], s[50:51] neg_lo:[1,0,0] neg_hi:[1,0,0]
    v_pk_fma_f32 v[122:123], v[90:91], v[90:91], s[50:51] neg_lo:[1,0,0] neg_hi:[1,0,0]
    v_pk_fma_f32 v[124:125], v[92:93], v[92:93], s[50:51] neg_lo:[1,0,0] neg_hi:[1,0,0]
    v_pk_fma_f32 v[126:127], v[94:95], v[94:95], s[50:51] neg_lo:[1,0,0] neg_hi:[1,0,0]
    v_pk_mul_f32 v[120:121], v[88:89], v[120:121]
    v_pk_mul_f32 v[122:123], v[90:91], v[122:123]
    v_pk_mul_f32 v[124:125], v[92:93], v[124:125]
    v_pk_mul_f32 v[126:127], v[94:95], v[126:127]
    v_mfma_f32_16x16x32_bf16 v[72:75], v[144:147], v[48:51], 0
    v_cvt_pk_bf16_f32 v136, v104, v105
    v_cvt_pk_bf16_f32 v137, v106, v107
    v_mfma_f32_16x16x32_bf16 v[76:79], v[156:159], v[48:51], 0
    v_cvt_pk_bf16_f32 v138, v108, v109
    v_cvt_pk_bf16_f32 v139, v110, v111
    v_mfma_f32_16x16x32_bf16 v[72:75], v[148:151], v[52:55], v[72:75]
    v_exp_f32 v120, v120
    v_exp_f32 v121, v121
    v_mfma_f32_16x16x32_bf16 v[76:79], v[160:163], v[52:55], v[76:79]
    v_exp_f32 v122, v122
    v_exp_f32 v123, v123
    v_mfma_f32_16x16x32_bf16 v[72:75], v[152:155], v[56:59], v[72:75]
    v_exp_f32 v124, v124
    v_exp_f32 v125, v125
    v_mfma_f32_16x16x32_bf16 v[76:79], v[164:167], v[56:59], v[76:79]
    s_waitcnt lgkmcnt(0)
    v_exp_f32 v126, v126
    v_exp_f32 v127, v127
    v_cmp_gt_u32 vcc, 5, v249
    s_cbranch_vccnz L_slow11
L_back11:
    s_setprio 0
    ds_read_b64_tr_b16 v[144:145], v210 offset:0
    ds_read_b64_tr_b16 v[146:147], v210 offset:512
    ds_read_b64_tr_b16 v[148:149], v210 offset:4096
    ds_read_b64_tr_b16 v[150:151], v210 offset:4608
    ds_read_b64_tr_b16 v[152:153], v210 offset:8192
    ds_read_b64_tr_b16 v[154:155], v210 offset:8704
    ds_read_b64_tr_b16 v[156:157], v211 offset:0
    ds_read_b64_tr_b16 v[158:159], v211 offset:512
    ds_read_b64_tr_b16 v[160:161], v211 offset:4096
    ds_read_b64_tr_b16 v[162:163], v211 offset:4608
    ds_read_b64_tr_b16 v[164:165], v211 offset:8192
    ds_read_b64_tr_b16 v[166:167], v211 offset:8704
    s_add_u32 m0, s59, 86016
    s_add_u32 s43, s59, 36864
    buffer_load_dwordx4 v221, s[32:35], s43 offen offset:0 lds
    buffer_load_dwordx4 v222, s[32:35], s43 offen offset:1024 lds
    buffer_load_dwordx4 v223, s[32:35], s43 offen offset:2048 lds
    ds_read_b128 v[60:63], v225 offset:0
    ds_read_b128 v[64:67], v225 offset:64
    ds_read_b128 v[68:71], v225 offset:128
    s_setprio 1
    v_pk_fma_f32 v[120:121], v[120:121], s[48:49], s[48:49]
    v_pk_fma_f32 v[122:123], v[122:123], s[48:49], s[48:49]
    v_pk_fma_f32 v[124:125], v[124:125], s[48:49], s[48:49]
    v_pk_fma_f32 v[126:127], v[126:127], s[48:49], s[48:49]
    v_mfma_f32_16x16x32_bf16 v[0:3], v[168:171], v[136:139], v[0:3]
    v_rcp_f32 v120, v120
    v_rcp_f32 v121, v121
    v_mfma_f32_16x16x32_bf16 v[4:7], v[172:175], v[136:139], v[4:7]
    v_rcp_f32 v122, v122
    v_rcp_f32 v123, v123
    v_mfma_f32_16x16x32_bf16 v[8:11], v[176:179], v[136:139], v[8:11]
    v_rcp_f32 v124, v124
    v_mfma_f32_16x16x32_bf16 v[12:15], v[180:183], v[136:139], v[12:15]
    v_rcp_f32 v125, v125
    v_mfma_f32_16x16x32_bf16 v[16:19], v[184:187], v[136:139], v[16:19]
    v_rcp_f32 v126, v126
    v_mfma_f32_16x16x32_bf16 v[20:23], v[188:191], v[136:139], v[20:23]
    s_waitcnt lgkmcnt(0)
    v_rcp_f32 v127, v127
    s_waitcnt vmcnt(6)
    v_mov_b32 v254, 6
    ds_write_b32 v248, v254
    s_setprio 0
    ds_read_b64_tr_b16 v[168:169], v214 offset:0
    ds_read_b64_tr_b16 v[170:171], v214 offset:3072
    ds_read_b64_tr_b16 v[172:173], v215 offset:0
    ds_read_b64_tr_b16 v[174:175], v215 offset:3072
    ds_read_b64_tr_b16 v[176:177], v214 offset:64
    ds_read_b64_tr_b16 v[178:179], v214 offset:3136
    ds_read_b64_tr_b16 v[180:181], v215 offset:64
    ds_read_b64_tr_b16 v[182:183], v215 offset:3136
    ds_read_b64_tr_b16 v[184:185], v214 offset:128
    ds_read_b64_tr_b16 v[186:187], v214 offset:3200
    ds_read_b64_tr_b16 v[188:189], v215 offset:128
    ds_read_b64_tr_b16 v[190:191], v215 offset:3200
    s_add_u32 m0, s59, 98304
    s_add_u32 s43, s58, 512
    buffer_load_dwordx4 v220, s[28:31], s43 offen lds
    s_add_u32 m0, s59, 99328
    s_add_u32 s43, s58, 6656
    buffer_load_dwordx4 v224, s[28:31], s43 offen lds
    s_add_u32 m0, s59, 100352
    s_add_u32 s43, s58, 12800
    buffer_load_dwordx4 v220, s[28:31], s43 offen lds
    ds_read_b32 v249, v243 offset:16
    s_setprio 1
    v_pk_mul_f32 v[120:121], v[88:89], v[120:121]
    v_pk_mul_f32 v[122:123], v[90:91], v[122:123]
    v_pk_mul_f32 v[124:125], v[92:93], v[124:125]
    v_pk_mul_f32 v[126:127], v[94:95], v[126:127]
    v_pk_fma_f32 v[104:105], v[72:73], v[72:73], s[50:51] neg_lo:[1,0,0] neg_hi:[1,0,0]
    v_pk_fma_f32 v[106:107], v[74:75], v[74:75], s[50:51] neg_lo:[1,0,0] neg_hi:[1,0,0]
    v_pk_fma_f32 v[108:109], v[76:77], v[76:77], s[50:51] neg_lo:[1,0,0] neg_hi:[1,0,0]
    v_pk_fma_f32 v[110:111], v[78:79], v[78:79], s[50:51] neg_lo:[1,0,0] neg_hi:[1,0,0]
    v_pk_mul_f32 v[104:105], v[72:73], v[104:105]
    v_pk_mul_f32 v[106:107], v[74:75], v[106:107]
    v_pk_mul_f32 v[108:109], v[76:77], v[108:109]
    v_pk_mul_f32 v[110:111], v[78:79], v[110:111]
    v_mfma_f32_16x16x32_bf16 v[88:91], v[144:147], v[48:51], 0
    v_cvt_pk_bf16_f32 v136, v120, v121
    v_mfma_f32_16x16x32_bf16 v[92:95], v[156:159], v[48:51], 0
    v_cvt_pk_bf16_f32 v137, v122, v123
    v_mfma_f32_16x16x32_bf16 v[88:91], v[148:151], v[52:55], v[88:91]
    v_cvt_pk_bf16_f32 v138, v124, v125
    v_mfma_f32_16x16x32_bf16 v[92:95], v[160:163], v[52:55], v[92:95]
    v_cvt_pk_bf16_f32 v139, v126, v127
    v_mfma_f32_16x16x32_bf16 v[88:91], v[152:155], v[56:59], v[88:91]
    v_exp_f32 v104, v104
    v_mfma_f32_16x16x32_bf16 v[92:95], v[164:167], v[56:59], v[92:95]
    v_exp_f32 v105, v105
    v_mfma_f32_16x16x32_bf16 v[96:99], v[144:147], v[60:63], 0
    v_exp_f32 v106, v106
    v_mfma_f32_16x16x32_bf16 v[100:103], v[156:159], v[60:63], 0
    v_exp_f32 v107, v107
    v_mfma_f32_16x16x32_bf16 v[96:99], v[148:151], v[64:67], v[96:99]
    v_exp_f32 v108, v108
    v_mfma_f32_16x16x32_bf16 v[100:103], v[160:163], v[64:67], v[100:103]
    v_exp_f32 v109, v109
    v_mfma_f32_16x16x32_bf16 v[96:99], v[152:155], v[68:71], v[96:99]
    v_exp_f32 v110, v110
    v_mfma_f32_16x16x32_bf16 v[100:103], v[164:167], v[68:71], v[100:103]
    s_waitcnt lgkmcnt(0)
    v_exp_f32 v111, v111
    v_cmp_gt_u32 vcc, 6, v249
    s_cbranch_vccnz L_slow12
L_back12:
    s_setprio 0
    ds_read_b64_tr_b16 v[144:145], v204 offset:49152
    ds_read_b64_tr_b16 v[146:147], v204 offset:49664
    ds_read_b64_tr_b16 v[148:149], v204 offset:53248
    ds_read_b64_tr_b16 v[150:151], v204 offset:53760
    ds_read_b64_tr_b16 v[152:153], v204 offset:57344
    ds_read_b64_tr_b16 v[154:155], v204 offset:57856
    ds_read_b64_tr_b16 v[156:157], v205 offset:49152
    ds_read_b64_tr_b16 v[158:159], v205 offset:49664
    ds_read_b64_tr_b16 v[160:161], v205 offset:53248
    ds_read_b64_tr_b16 v[162:163], v205 offset:53760
    ds_read_b64_tr_b16 v[164:165], v205 offset:57344
    ds_read_b64_tr_b16 v[166:167], v205 offset:57856
    s_add_u32 m0, s59, 110592
    s_add_u32 s43, s59, 49152
    buffer_load_dwordx4 v221, s[32:35], s43 offen offset:0 lds
    buffer_load_dwordx4 v222, s[32:35], s43 offen offset:1024 lds
    buffer_load_dwordx4 v223, s[32:35], s43 offen offset:2048 lds
    s_setprio 1
    v_pk_fma_f32 v[104:105], v[104:105], s[48:49], s[48:49]
    v_pk_fma_f32 v[106:107], v[106:107], s[48:49], s[48:49]
    v_pk_fma_f32 v[108:109], v[108:109], s[48:49], s[48:49]
    v_pk_fma_f32 v[110:111], v[110:111], s[48:49], s[48:49]
    v_mfma_f32_16x16x32_bf16 v[0:3], v[168:171], v[136:139], v[0:3]
    v_rcp_f32 v104, v104
    v_rcp_f32 v105, v105
    v_mfma_f32_16x16x32_bf16 v[4:7], v[172:175], v[136:139], v[4:7]
    v_rcp_f32 v106, v106
    v_rcp_f32 v107, v107
    v_mfma_f32_16x16x32_bf16 v[8:11], v[176:179], v[136:139], v[8:11]
    v_rcp_f32 v108, v108
    v_mfma_f32_16x16x32_bf16 v[12:15], v[180:183], v[136:139], v[12:15]
    v_rcp_f32 v109, v109
    v_mfma_f32_16x16x32_bf16 v[16:19], v[184:187], v[136:139], v[16:19]
    v_rcp_f32 v110, v110
    v_mfma_f32_16x16x32_bf16 v[20:23], v[188:191], v[136:139], v[20:23]
    s_waitcnt lgkmcnt(0)
    v_rcp_f32 v111, v111
    s_setprio 0
    ds_read_b64_tr_b16 v[168:169], v216 offset:0
    ds_read_b64_tr_b16 v[170:171], v216 offset:3072
    ds_read_b64_tr_b16 v[172:173], v217 offset:0
    ds_read_b64_tr_b16 v[174:175], v217 offset:3072
    ds_read_b64_tr_b16 v[176:177], v216 offset:64
    ds_read_b64_tr_b16 v[178:179], v216 offset:3136
    ds_read_b64_tr_b16 v[180:181], v217 offset:64
    ds_read_b64_tr_b16 v[182:183], v217 offset:3136
    ds_read_b64_tr_b16 v[184:185], v216 offset:128
    ds_read_b64_tr_b16 v[186:187], v216 offset:3200
    ds_read_b64_tr_b16 v[188:189], v217 offset:128
    ds_read_b64_tr_b16 v[190:191], v217 offset:3200
    s_add_u32 m0, s59, 122880
    s_add_u32 s43, s58, 640
    buffer_load_dwordx4 v220, s[28:31], s43 offen lds
    s_add_u32 m0, s59, 123904
    s_add_u32 s43, s58, 6784
    buffer_load_dwordx4 v224, s[28:31], s43 offen lds
    s_add_u32 m0, s59, 124928
    s_add_u32 s43, s58, 12928
    buffer_load_dwordx4 v220, s[28:31], s43 offen lds
    s_setprio 1
    v_pk_mul_f32 v[104:105], v[72:73], v[104:105]
    v_pk_mul_f32 v[106:107], v[74:75], v[106:107]
    v_pk_mul_f32 v[108:109], v[76:77], v[108:109]
    v_pk_mul_f32 v[110:111], v[78:79], v[110:111]
    v_pk_fma_f32 v[120:121], v[88:89], v[88:89], s[50:51] neg_lo:[1,0,0] neg_hi:[1,0,0]
    v_pk_fma_f32 v[122:123], v[90:91], v[90:91], s[50:51] neg_lo:[1,0,0] neg_hi:[1,0,0]
    v_pk_fma_f32 v[124:125], v[92:93], v[92:93], s[50:51] neg_lo:[1,0,0] neg_hi:[1,0,0]
    v_pk_fma_f32 v[126:127], v[94:95], v[94:95], s[50:51] neg_lo:[1,0,0] neg_hi:[1,0,0]
    v_pk_fma_f32 v[128:129], v[96:97], v[96:97], s[50:51] neg_lo:[1,0,0] neg_hi:[1,0,0]
    v_pk_fma_f32 v[130:131], v[98:99], v[98:99], s[50:51] neg_lo:[1,0,0] neg_hi:[1,0,0]
    v_pk_fma_f32 v[132:133], v[100:101], v[100:101], s[50:51] neg_lo:[1,0,0] neg_hi:[1,0,0]
    v_pk_fma_f32 v[134:135], v[102:103], v[102:103], s[50:51] neg_lo:[1,0,0] neg_hi:[1,0,0]
    v_pk_mul_f32 v[120:121], v[88:89], v[120:121]
    v_pk_mul_f32 v[122:123], v[90:91], v[122:123]
    v_pk_mul_f32 v[124:125], v[92:93], v[124:125]
    v_pk_mul_f32 v[126:127], v[94:95], v[126:127]
    v_pk_mul_f32 v[128:129], v[96:97], v[128:129]
    v_pk_mul_f32 v[130:131], v[98:99], v[130:131]
    v_pk_mul_f32 v[132:133], v[100:101], v[132:133]
    v_pk_mul_f32 v[134:135], v[102:103], v[134:135]
    v_mfma_f32_16x16x32_bf16 v[72:75], v[144:147], v[48:51], 0
    v_cvt_pk_bf16_f32 v136, v104, v105
    v_cvt_pk_bf16_f32 v137, v106, v107
    v_cvt_pk_bf16_f32 v138, v108, v109
    v_cvt_pk_bf16_f32 v139, v110, v111
    v_mfma_f32_16x16x32_bf16 v[76:79], v[156:159], v[48:51], 0
    v_exp_f32 v120, v120
    v_exp_f32 v121, v121
    v_exp_f32 v122, v122
    v_exp_f32 v123, v123
    v_mfma_f32_16x16x32_bf16 v[72:75], v[148:151], v[52:55], v[72:75]
    v_exp_f32 v124, v124
    v_exp_f32 v125, v125
    v_exp_f32 v126, v126
    v_mfma_f32_16x16x32_bf16 v[76:79], v[160:163], v[52:55], v[76:79]
    v_exp_f32 v127, v127
    v_exp_f32 v128, v128
    v_exp_f32 v129, v129
    v_mfma_f32_16x16x32_bf16 v[72:75], v[152:155], v[56:59], v[72:75]
    v_exp_f32 v130, v130
    v_exp_f32 v131, v131
    v_exp_f32 v132, v132
    v_mfma_f32_16x16x32_bf16 v[76:79], v[164:167], v[56:59], v[76:79]
    s_waitcnt lgkmcnt(0)
    v_exp_f32 v133, v133
    v_exp_f32 v134, v134
    v_exp_f32 v135, v135
    s_waitcnt vmcnt(9)
    v_mov_b32 v254, 7
    ds_write_b32 v248, v254
    s_setprio 0
    ds_read_b64_tr_b16 v[144:145], v206 offset:49152
    ds_read_b64_tr_b16 v[146:147], v206 offset:49664
    ds_read_b64_tr_b16 v[148:149], v206 offset:53248
    ds_read_b64_tr_b16 v[150:151], v206 offset:53760
    ds_read_b64_tr_b16 v[152:153], v206 offset:57344
    ds_read_b64_tr_b16 v[154:155], v206 offset:57856
    ds_read_b64_tr_b16 v[156:157], v207 offset:49152
    ds_read_b64_tr_b16 v[158:159], v207 offset:49664
    ds_read_b64_tr_b16 v[160:161], v207 offset:53248
    ds_read_b64_tr_b16 v[162:163], v207 offset:53760
    ds_read_b64_tr_b16 v[164:165], v207 offset:57344
    ds_read_b64_tr_b16 v[166:167], v207 offset:57856
    s_add_u32 m0, s59, 135168
    s_add_u32 s43, s59, 61440
    buffer_load_dwordx4 v221, s[32:35], s43 offen offset:0 lds
    buffer_load_dwordx4 v222, s[32:35], s43 offen offset:1024 lds
    buffer_load_dwordx4 v223, s[32:35], s43 offen offset:2048 lds
    s_setprio 1
    v_pk_fma_f32 v[120:121], v[120:121], s[48:49], s[48:49]
    v_pk_fma_f32 v[122:123], v[122:123], s[48:49], s[48:49]
    v_pk_fma_f32 v[124:125], v[124:125], s[48:49], s[48:49]
    v_pk_fma_f32 v[126:127], v[126:127], s[48:49], s[48:49]
    v_pk_fma_f32 v[128:129], v[128:129], s[48:49], s[48:49]
    v_pk_fma_f32 v[130:131], v[130:131], s[48:49], s[48:49]
    v_pk_fma_f32 v[132:133], v[132:133], s[48:49], s[48:49]
    v_pk_fma_f32 v[134:135], v[134:135], s[48:49], s[48:49]
    v_mfma_f32_16x16x32_bf16 v[0:3], v[168:171], v[136:139], v[0:3]
    v_rcp_f32 v120, v120
    v_rcp_f32 v121, v121
    v_rcp_f32 v122, v122
    v_mfma_f32_16x16x32_bf16 v[4:7], v[172:175], v[136:139], v[4:7]
    v_rcp_f32 v123, v123
    v_rcp_f32 v124, v124
    v_rcp_f32 v125, v125
    v_mfma_f32_16x16x32_bf16 v[8:11], v[176:179], v[136:139], v[8:11]
    v_rcp_f32 v126, v126
    v_rcp_f32 v127, v127
    v_rcp_f32 v128, v128
    v_mfma_f32_16x16x32_bf16 v[12:15], v[180:183], v[136:139], v[12:15]
    v_rcp_f32 v129, v129
    v_rcp_f32 v130, v130
    v_rcp_f32 v131, v131
    v_mfma_f32_16x16x32_bf16 v[16:19], v[184:187], v[136:139], v[16:19]
    v_rcp_f32 v132, v132
    v_rcp_f32 v133, v133
    v_mfma_f32_16x16x32_bf16 v[20:23], v[188:191], v[136:139], v[20:23]
    s_waitcnt lgkmcnt(0)
    v_rcp_f32 v134, v134
    v_rcp_f32 v135, v135
    s_setprio 0
    ds_read_b64_tr_b16 v[168:169], v218 offset:0
    ds_read_b64_tr_b16 v[170:171], v218 offset:3072
    ds_read_b64_tr_b16 v[172:173], v219 offset:0
    ds_read_b64_tr_b16 v[174:175], v219 offset:3072
    ds_read_b64_tr_b16 v[176:177], v218 offset:64
    ds_read_b64_tr_b16 v[178:179], v218 offset:3136
    ds_read_b64_tr_b16 v[180:181], v219 offset:64
    ds_read_b64_tr_b16 v[182:183], v219 offset:3136
    ds_read_b64_tr_b16 v[184:185], v218 offset:128
    ds_read_b64_tr_b16 v[186:187], v218 offset:3200
    ds_read_b64_tr_b16 v[188:189], v219 offset:128
    ds_read_b64_tr_b16 v[190:191], v219 offset:3200
    s_setprio 1
    v_pk_mul_f32 v[120:121], v[88:89], v[120:121]
    v_pk_mul_f32 v[122:123], v[90:91], v[122:123]
    v_pk_mul_f32 v[124:125], v[92:93], v[124:125]
    v_pk_mul_f32 v[126:127], v[94:95], v[126:127]
    v_pk_mul_f32 v[128:129], v[96:97], v[128:129]
    v_pk_mul_f32 v[130:131], v[98:99], v[130:131]
    v_pk_mul_f32 v[132:133], v[100:101], v[132:133]
    v_pk_mul_f32 v[134:135], v[102:103], v[134:135]
    v_pk_fma_f32 v[104:105], v[72:73], v[72:73], s[50:51] neg_lo:[1,0,0] neg_hi:[1,0,0]
    v_pk_fma_f32 v[106:107], v[74:75], v[74:75], s[50:51] neg_lo:[1,0,0] neg_hi:[1,0,0]
    v_pk_fma_f32 v[108:109], v[76:77], v[76:77], s[50:51] neg_lo:[1,0,0] neg_hi:[1,0,0]
    v_pk_fma_f32 v[110:111], v[78:79], v[78:79], s[50:51] neg_lo:[1,0,0] neg_hi:[1,0,0]
    v_pk_mul_f32 v[104:105], v[72:73], v[104:105]
    v_pk_mul_f32 v[106:107], v[74:75], v[106:107]
    v_pk_mul_f32 v[108:109], v[76:77], v[108:109]
    v_pk_mul_f32 v[110:111], v[78:79], v[110:111]
    v_mfma_f32_16x16x32_bf16 v[88:91], v[144:147], v[48:51], 0
    v_cvt_pk_bf16_f32 v136, v120, v121
    v_cvt_pk_bf16_f32 v137, v122, v123
    v_mfma_f32_16x16x32_bf16 v[92:95], v[156:159], v[48:51], 0
    v_cvt_pk_bf16_f32 v138, v124, v125
    v_cvt_pk_bf16_f32 v139, v126, v127
    v_mfma_f32_16x16x32_bf16 v[88:91], v[148:151], v[52:55], v[88:91]
    v_cvt_pk_bf16_f32 v140, v128, v129
    v_cvt_pk_bf16_f32 v141, v130, v131
    v_mfma_f32_16x16x32_bf16 v[92:95], v[160:163], v[52:55], v[92:95]
    v_cvt_pk_bf16_f32 v142, v132, v133
    v_cvt_pk_bf16_f32 v143, v134, v135
    v_mfma_f32_16x16x32_bf16 v[88:91], v[152:155], v[56:59], v[88:91]
    v_exp_f32 v104, v104
    v_mfma_f32_16x16x32_bf16 v[92:95], v[164:167], v[56:59], v[92:95]
    v_exp_f32 v105, v105
    v_mfma_f32_16x16x32_bf16 v[96:99], v[144:147], v[60:63], 0
    v_exp_f32 v106, v106
    v_mfma_f32_16x16x32_bf16 v[100:103], v[156:159], v[60:63], 0
    v_exp_f32 v107, v107
    v_mfma_f32_16x16x32_bf16 v[96:99], v[148:151], v[64:67], v[96:99]
    v_exp_f32 v108, v108
    v_mfma_f32_16x16x32_bf16 v[100:103], v[160:163], v[64:67], v[100:103]
    v_exp_f32 v109, v109
    v_mfma_f32_16x16x32_bf16 v[96:99], v[152:155], v[68:71], v[96:99]
    v_exp_f32 v110, v110
    v_mfma_f32_16x16x32_bf16 v[100:103], v[164:167], v[68:71], v[100:103]
    s_waitcnt lgkmcnt(0)
    v_exp_f32 v111, v111
    s_setprio 0
    ds_read_b64_tr_b16 v[144:145], v208 offset:49152
    ds_read_b64_tr_b16 v[146:147], v208 offset:49664
    ds_read_b64_tr_b16 v[148:149], v208 offset:53248
    ds_read_b64_tr_b16 v[150:151], v208 offset:53760
    ds_read_b64_tr_b16 v[152:153], v208 offset:57344
    ds_read_b64_tr_b16 v[154:155], v208 offset:57856
    ds_read_b64_tr_b16 v[156:157], v209 offset:49152
    ds_read_b64_tr_b16 v[158:159], v209 offset:49664
    ds_read_b64_tr_b16 v[160:161], v209 offset:53248
    ds_read_b64_tr_b16 v[162:163], v209 offset:53760
    ds_read_b64_tr_b16 v[164:165], v209 offset:57344
    ds_read_b64_tr_b16 v[166:167], v209 offset:57856
    ds_read_b32 v249, v243 offset:16
    s_setprio 1
    v_pk_fma_f32 v[104:105], v[104:105], s[48:49], s[48:49]
    v_pk_fma_f32 v[106:107], v[106:107], s[48:49], s[48:49]
    v_pk_fma_f32 v[108:109], v[108:109], s[48:49], s[48:49]
    v_pk_fma_f32 v[110:111], v[110:111], s[48:49], s[48:49]
    v_mfma_f32_16x16x32_bf16 v[0:3], v[168:171], v[136:139], v[0:3]
    v_rcp_f32 v104, v104
    v_mfma_f32_16x16x32_bf16 v[4:7], v[172:175], v[136:139], v[4:7]
    v_rcp_f32 v105, v105
    v_mfma_f32_16x16x32_bf16 v[8:11], v[176:179], v[136:139], v[8:11]
    v_rcp_f32 v106, v106
    v_mfma_f32_16x16x32_bf16 v[12:15], v[180:183], v[136:139], v[12:15]
    v_rcp_f32 v107, v107
    v_mfma_f32_16x16x32_bf16 v[16:19], v[184:187], v[136:139], v[16:19]
    v_rcp_f32 v108, v108
    v_mfma_f32_16x16x32_bf16 v[20:23], v[188:191], v[136:139], v[20:23]
    v_rcp_f32 v109, v109
    v_mfma_f32_16x16x32_bf16 v[24:27], v[168:171], v[140:143], v[24:27]
    v_rcp_f32 v110, v110
    v_mfma_f32_16x16x32_bf16 v[28:31], v[172:175], v[140:143], v[28:31]
    v_rcp_f32 v111, v111
    v_mfma_f32_16x16x32_bf16 v[32:35], v[176:179], v[140:143], v[32:35]
    v_mfma_f32_16x16x32_bf16 v[36:39], v[180:183], v[140:143], v[36:39]
    v_mfma_f32_16x16x32_bf16 v[40:43], v[184:187], v[140:143], v[40:43]
    v_mfma_f32_16x16x32_bf16 v[44:47], v[188:191], v[140:143], v[44:47]
    s_waitcnt lgkmcnt(0)
    v_cmp_gt_u32 vcc, 7, v249
    s_cbranch_vccnz L_slow13
L_back13:
    s_waitcnt vmcnt(0)
    v_mov_b32 v254, 8
    ds_write_b32 v248, v254
    s_setprio 0
    ds_read_b64_tr_b16 v[168:169], v212 offset:49152
    ds_read_b64_tr_b16 v[170:171], v212 offset:52224
    ds_read_b64_tr_b16 v[172:173], v213 offset:49152
    ds_read_b64_tr_b16 v[174:175], v213 offset:52224
    ds_read_b64_tr_b16 v[176:177], v212 offset:49216
    ds_read_b64_tr_b16 v[178:179], v212 offset:52288
    ds_read_b64_tr_b16 v[180:181], v213 offset:49216
    ds_read_b64_tr_b16 v[182:183], v213 offset:52288
    ds_read_b64_tr_b16 v[184:185], v212 offset:49280
    ds_read_b64_tr_b16 v[186:187], v212 offset:52352
    ds_read_b64_tr_b16 v[188:189], v213 offset:49280
    ds_read_b64_tr_b16 v[190:191], v213 offset:52352
    s_setprio 1
    v_pk_mul_f32 v[104:105], v[72:73], v[104:105]
    v_pk_mul_f32 v[106:107], v[74:75], v[106:107]
    v_pk_mul_f32 v[108:109], v[76:77], v[108:109]
    v_pk_mul_f32 v[110:111], v[78:79], v[110:111]
    v_pk_fma_f32 v[120:121], v[88:89], v[88:89], s[50:51] neg_lo:[1,0,0] neg_hi:[1,0,0]
    v_pk_fma_f32 v[122:123], v[90:91], v[90:91], s[50:51] neg_lo:[1,0,0] neg_hi:[1,0,0]
    v_pk_fma_f32 v[124:125], v[92:93], v[92:93], s[50:51] neg_lo:[1,0,0] neg_hi:[1,0,0]
    v_pk_fma_f32 v[126:127], v[94:95], v[94:95], s[50:51] neg_lo:[1,0,0] neg_hi:[1,0,0]
    v_pk_fma_f32 v[128:129], v[96:97], v[96:97], s[50:51] neg_lo:[1,0,0] neg_hi:[1,0,0]
    v_pk_fma_f32 v[130:131], v[98:99], v[98:99], s[50:51] neg_lo:[1,0,0] neg_hi:[1,0,0]
    v_pk_fma_f32 v[132:133], v[100:101], v[100:101], s[50:51] neg_lo:[1,0,0] neg_hi:[1,0,0]
    v_pk_fma_f32 v[134:135], v[102:103], v[102:103], s[50:51] neg_lo:[1,0,0] neg_hi:[1,0,0]
    v_pk_mul_f32 v[120:121], v[88:89], v[120:121]
    v_pk_mul_f32 v[122:123], v[90:91], v[122:123]
    v_pk_mul_f32 v[124:125], v[92:93], v[124:125]
    v_pk_mul_f32 v[126:127], v[94:95], v[126:127]
    v_pk_mul_f32 v[128:129], v[96:97], v[128:129]
    v_pk_mul_f32 v[130:131], v[98:99], v[130:131]
    v_pk_mul_f32 v[132:133], v[100:101], v[132:133]
    v_pk_mul_f32 v[134:135], v[102:103], v[134:135]
    v_mfma_f32_16x16x32_bf16 v[72:75], v[144:147], v[48:51], 0
    v_cvt_pk_bf16_f32 v136, v104, v105
    v_cvt_pk_bf16_f32 v137, v106, v107
    v_cvt_pk_bf16_f32 v138, v108, v109
    v_cvt_pk_bf16_f32 v139, v110, v111
    v_mfma_f32_16x16x32_bf16 v[76:79], v[156:159], v[48:51], 0
    v_exp_f32 v120, v120
    v_exp_f32 v121, v121
    v_exp_f32 v122, v122
    v_exp_f32 v123, v123
    v_mfma_f32_16x16x32_bf16 v[72:75], v[148:151], v[52:55], v[72:75]
    v_exp_f32 v124, v124
    v_exp_f32 v125, v125
    v_exp_f32 v126, v126
    v_mfma_f32_16x16x32_bf16 v[76:79], v[160:163], v[52:55], v[76:79]
    v_exp_f32 v127, v127
    v_exp_f32 v128, v128
    v_exp_f32 v129, v129
    v_mfma_f32_16x16x32_bf16 v[72:75], v[152:155], v[56:59], v[72:75]
    v_exp_f32 v130, v130
    v_exp_f32 v131, v131
    v_exp_f32 v132, v132
    v_mfma_f32_16x16x32_bf16 v[76:79], v[164:167], v[56:59], v[76:79]
    s_waitcnt lgkmcnt(0)
    v_exp_f32 v133, v133
    v_exp_f32 v134, v134
    v_exp_f32 v135, v135
    s_setprio 0
    ds_read_b64_tr_b16 v[144:145], v210 offset:49152
    ds_read_b64_tr_b16 v[146:147], v210 offset:49664
    ds_read_b64_tr_b16 v[148:149], v210 offset:53248
    ds_read_b64_tr_b16 v[150:151], v210 offset:53760
    ds_read_b64_tr_b16 v[152:153], v210 offset:57344
    ds_read_b64_tr_b16 v[154:155], v210 offset:57856
    ds_read_b64_tr_b16 v[156:157], v211 offset:49152
    ds_read_b64_tr_b16 v[158:159], v211 offset:49664
    ds_read_b64_tr_b16 v[160:161], v211 offset:53248
    ds_read_b64_tr_b16 v[162:163], v211 offset:53760
    ds_read_b64_tr_b16 v[164:165], v211 offset:57344
    ds_read_b64_tr_b16 v[166:167], v211 offset:57856
    s_setprio 1
    v_pk_fma_f32 v[120:121], v[120:121], s[48:49], s[48:49]
    v_pk_fma_f32 v[122:123], v[122:123], s[48:49], s[48:49]
    v_pk_fma_f32 v[124:125], v[124:125], s[48:49], s[48:49]
    v_pk_fma_f32 v[126:127], v[126:127], s[48:49], s[48:49]
    v_pk_fma_f32 v[128:129], v[128:129], s[48:49], s[48:49]
    v_pk_fma_f32 v[130:131], v[130:131], s[48:49], s[48:49]
    v_pk_fma_f32 v[132:133], v[132:133], s[48:49], s[48:49]
    v_pk_fma_f32 v[134:135], v[134:135], s[48:49], s[48:49]
    v_mfma_f32_16x16x32_bf16 v[0:3], v[168:171], v[136:139], v[0:3]
    v_rcp_f32 v120, v120
    v_rcp_f32 v121, v121
    v_rcp_f32 v122, v122
    v_mfma_f32_16x16x32_bf16 v[4:7], v[172:175], v[136:139], v[4:7]
    v_rcp_f32 v123, v123
    v_rcp_f32 v124, v124
    v_rcp_f32 v125, v125
    v_mfma_f32_16x16x32_bf16 v[8:11], v[176:179], v[136:139], v[8:11]
    v_rcp_f32 v126, v126
    v_rcp_f32 v127, v127
    v_rcp_f32 v128, v128
    v_mfma_f32_16x16x32_bf16 v[12:15], v[180:183], v[136:139], v[12:15]
    v_rcp_f32 v129, v129
    v_rcp_f32 v130, v130
    v_rcp_f32 v131, v131
    v_mfma_f32_16x16x32_bf16 v[16:19], v[184:187], v[136:139], v[16:19]
    v_rcp_f32 v132, v132
    v_rcp_f32 v133, v133
    v_mfma_f32_16x16x32_bf16 v[20:23], v[188:191], v[136:139], v[20:23]
    s_waitcnt lgkmcnt(0)
    v_rcp_f32 v134, v134
    v_rcp_f32 v135, v135
    s_setprio 0
    ds_read_b64_tr_b16 v[168:169], v214 offset:49152
    ds_read_b64_tr_b16 v[170:171], v214 offset:52224
    ds_read_b64_tr_b16 v[172:173], v215 offset:49152
    ds_read_b64_tr_b16 v[174:175], v215 offset:52224
    ds_read_b64_tr_b16 v[176:177], v214 offset:49216
    ds_read_b64_tr_b16 v[178:179], v214 offset:52288
    ds_read_b64_tr_b16 v[180:181], v215 offset:49216
    ds_read_b64_tr_b16 v[182:183], v215 offset:52288
    ds_read_b64_tr_b16 v[184:185], v214 offset:49280
    ds_read_b64_tr_b16 v[186:187], v214 offset:52352
    ds_read_b64_tr_b16 v[188:189], v215 offset:49280
    ds_read_b64_tr_b16 v[190:191], v215 offset:52352
    ds_read_b32 v249, v243 offset:16
    s_setprio 1
    v_pk_mul_f32 v[120:121], v[88:89], v[120:121]
    v_pk_mul_f32 v[122:123], v[90:91], v[122:123]
    v_pk_mul_f32 v[124:125], v[92:93], v[124:125]
    v_pk_mul_f32 v[126:127], v[94:95], v[126:127]
    v_pk_mul_f32 v[128:129], v[96:97], v[128:129]
    v_pk_mul_f32 v[130:131], v[98:99], v[130:131]
    v_pk_mul_f32 v[132:133], v[100:101], v[132:133]
    v_pk_mul_f32 v[134:135], v[102:103], v[134:135]
    v_pk_fma_f32 v[104:105], v[72:73], v[72:73], s[50:51] neg_lo:[1,0,0] neg_hi:[1,0,0]
    v_pk_fma_f32 v[106:107], v[74:75], v[74:75], s[50:51] neg_lo:[1,0,0] neg_hi:[1,0,0]
    v_pk_fma_f32 v[108:109], v[76:77], v[76:77], s[50:51] neg_lo:[1,0,0] neg_hi:[1,0,0]
    v_pk_fma_f32 v[110:111], v[78:79], v[78:79], s[50:51] neg_lo:[1,0,0] neg_hi:[1,0,0]
    v_pk_mul_f32 v[104:105], v[72:73], v[104:105]
    v_pk_mul_f32 v[106:107], v[74:75], v[106:107]
    v_pk_mul_f32 v[108:109], v[76:77], v[108:109]
    v_pk_mul_f32 v[110:111], v[78:79], v[110:111]
    v_add_u32 v204, 98304, v204
    v_add_u32 v205, 98304, v205
    v_add_u32 v206, 98304, v206
    v_add_u32 v207, 98304, v207
    v_add_u32 v208, 98304, v208
    v_add_u32 v209, 98304, v209
    v_add_u32 v210, 98304, v210
    v_add_u32 v211, 98304, v211
    v_mfma_f32_16x16x32_bf16 v[88:91], v[144:147], v[48:51], 0
    v_cvt_pk_bf16_f32 v136, v120, v121
    v_cvt_pk_bf16_f32 v137, v122, v123
    v_cvt_pk_bf16_f32 v138, v124, v125
    v_mfma_f32_16x16x32_bf16 v[92:95], v[156:159], v[48:51], 0
    v_cvt_pk_bf16_f32 v139, v126, v127
    v_cvt_pk_bf16_f32 v140, v128, v129
    v_cvt_pk_bf16_f32 v141, v130, v131
    v_mfma_f32_16x16x32_bf16 v[88:91], v[148:151], v[52:55], v[88:91]
    v_cvt_pk_bf16_f32 v142, v132, v133
    v_cvt_pk_bf16_f32 v143, v134, v135
    v_exp_f32 v104, v104
    v_mfma_f32_16x16x32_bf16 v[92:95], v[160:163], v[52:55], v[92:95]
    v_exp_f32 v105, v105
    v_exp_f32 v106, v106
    v_exp_f32 v107, v107
    v_mfma_f32_16x16x32_bf16 v[88:91], v[152:155], v[56:59], v[88:91]
    v_exp_f32 v108, v108
    v_exp_f32 v109, v109
    v_mfma_f32_16x16x32_bf16 v[92:95], v[164:167], v[56:59], v[92:95]
    s_waitcnt lgkmcnt(0)
    v_exp_f32 v110, v110
    v_exp_f32 v111, v111
    v_cmp_gt_u32 vcc, 8, v249
    s_cbranch_vccnz L_slow14
L_back14:
    s_setprio 0
    ds_read_b64_tr_b16 v[144:145], v204 offset:0
    ds_read_b64_tr_b16 v[146:147], v204 offset:512
    ds_read_b64_tr_b16 v[148:149], v204 offset:4096
    ds_read_b64_tr_b16 v[150:151], v204 offset:4608
    ds_read_b64_tr_b16 v[152:153], v204 offset:8192
    ds_read_b64_tr_b16 v[154:155], v204 offset:8704
    ds_read_b64_tr_b16 v[156:157], v205 offset:0
    ds_read_b64_tr_b16 v[158:159], v205 offset:512
    ds_read_b64_tr_b16 v[160:161], v205 offset:4096
    ds_read_b64_tr_b16 v[162:163], v205 offset:4608
    ds_read_b64_tr_b16 v[164:165], v205 offset:8192
    ds_read_b64_tr_b16 v[166:167], v205 offset:8704
    s_setprio 1
    v_pk_fma_f32 v[104:105], v[104:105], s[48:49], s[48:49]
    v_pk_fma_f32 v[106:107], v[106:107], s[48:49], s[48:49]
    v_pk_fma_f32 v[108:109], v[108:109], s[48:49], s[48:49]
    v_pk_fma_f32 v[110:111], v[110:111], s[48:49], s[48:49]
    v_mfma_f32_16x16x32_bf16 v[0:3], v[168:171], v[136:139], v[0:3]
    v_rcp_f32 v104, v104
    v_mfma_f32_16x16x32_bf16 v[4:7], v[172:175], v[136:139], v[4:7]
    v_rcp_f32 v105, v105
    v_mfma_f32_16x16x32_bf16 v[8:11], v[176:179], v[136:139], v[8:11]
    v_rcp_f32 v106, v106
    v_mfma_f32_16x16x32_bf16 v[12:15], v[180:183], v[136:139], v[12:15]
    v_rcp_f32 v107, v107
    v_mfma_f32_16x16x32_bf16 v[16:19], v[184:187], v[136:139], v[16:19]
    v_rcp_f32 v108, v108
    v_mfma_f32_16x16x32_bf16 v[20:23], v[188:191], v[136:139], v[20:23]
    v_rcp_f32 v109, v109
    v_mfma_f32_16x16x32_bf16 v[24:27], v[168:171], v[140:143], v[24:27]
    v_rcp_f32 v110, v110
    v_mfma_f32_16x16x32_bf16 v[28:31], v[172:175], v[140:143], v[28:31]
    v_rcp_f32 v111, v111
    v_mfma_f32_16x16x32_bf16 v[32:35], v[176:179], v[140:143], v[32:35]
    v_mfma_f32_16x16x32_bf16 v[36:39], v[180:183], v[140:143], v[36:39]
    v_mfma_f32_16x16x32_bf16 v[40:43], v[184:187], v[140:143], v[40:43]
    v_mfma_f32_16x16x32_bf16 v[44:47], v[188:191], v[140:143], v[44:47]
    s_waitcnt lgkmcnt(0)
    s_setprio 0
    ds_read_b64_tr_b16 v[168:169], v216 offset:49152
    ds_read_b64_tr_b16 v[170:171], v216 offset:52224
    ds_read_b64_tr_b16 v[172:173], v217 offset:49152
    ds_read_b64_tr_b16 v[174:175], v217 offset:52224
    ds_read_b64_tr_b16 v[176:177], v216 offset:49216
    ds_read_b64_tr_b16 v[178:179], v216 offset:52288
    ds_read_b64_tr_b16 v[180:181], v217 offset:49216
    ds_read_b64_tr_b16 v[182:183], v217 offset:52288
    ds_read_b64_tr_b16 v[184:185], v216 offset:49280
    ds_read_b64_tr_b16 v[186:187], v216 offset:52352
    ds_read_b64_tr_b16 v[188:189], v217 offset:49280
    ds_read_b64_tr_b16 v[190:191], v217 offset:52352
    s_setprio 1
    v_pk_mul_f32 v[104:105], v[72:73], v[104:105]
    v_pk_mul_f32 v[106:107], v[74:75], v[106:107]
    v_pk_mul_f32 v[108:109], v[76:77], v[108:109]
    v_pk_mul_f32 v[110:111], v[78:79], v[110:111]
    v_pk_fma_f32 v[120:121], v[88:89], v[88:89], s[50:51] neg_lo:[1,0,0] neg_hi:[1,0,0]
    v_pk_fma_f32 v[122:123], v[90:91], v[90:91], s[50:51] neg_lo:[1,0,0] neg_hi:[1,0,0]
    v_pk_fma_f32 v[124:125], v[92:93], v[92:93], s[50:51] neg_lo:[1,0,0] neg_hi:[1,0,0]
    v_pk_fma_f32 v[126:127], v[94:95], v[94:95], s[50:51] neg_lo:[1,0,0] neg_hi:[1,0,0]
    v_pk_mul_f32 v[120:121], v[88:89], v[120:121]
    v_pk_mul_f32 v[122:123], v[90:91], v[122:123]
    v_pk_mul_f32 v[124:125], v[92:93], v[124:125]
    v_pk_mul_f32 v[126:127], v[94:95], v[126:127]
    v_mfma_f32_16x16x32_bf16 v[72:75], v[144:147], v[48:51], 0
    v_cvt_pk_bf16_f32 v136, v104, v105
    v_mfma_f32_16x16x32_bf16 v[76:79], v[156:159], v[48:51], 0
    v_cvt_pk_bf16_f32 v137, v106, v107
    v_mfma_f32_16x16x32_bf16 v[72:75], v[148:151], v[52:55], v[72:75]
    v_cvt_pk_bf16_f32 v138, v108, v109
    v_mfma_f32_16x16x32_bf16 v[76:79], v[160:163], v[52:55], v[76:79]
    v_cvt_pk_bf16_f32 v139, v110, v111
    v_mfma_f32_16x16x32_bf16 v[72:75], v[152:155], v[56:59], v[72:75]
    v_exp_f32 v120, v120
    v_mfma_f32_16x16x32_bf16 v[76:79], v[164:167], v[56:59], v[76:79]
    v_exp_f32 v121, v121
    v_mfma_f32_16x16x32_bf16 v[80:83], v[144:147], v[60:63], 0
    v_exp_f32 v122, v122
    v_mfma_f32_16x16x32_bf16 v[84:87], v[156:159], v[60:63], 0
    v_exp_f32 v123, v123
    v_mfma_f32_16x16x32_bf16 v[80:83], v[148:151], v[64:67], v[80:83]
    v_exp_f32 v124, v124
    v_mfma_f32_16x16x32_bf16 v[84:87], v[160:163], v[64:67], v[84:87]
    v_exp_f32 v125, v125
    v_mfma_f32_16x16x32_bf16 v[80:83], v[152:155], v[68:71], v[80:83]
    v_exp_f32 v126, v126
    v_mfma_f32_16x16x32_bf16 v[84:87], v[164:167], v[68:71], v[84:87]
    s_waitcnt lgkmcnt(0)
    v_exp_f32 v127, v127
    s_setprio 0
    ds_read_b64_tr_b16 v[144:145], v206 offset:0
    ds_read_b64_tr_b16 v[146:147], v206 offset:512
    ds_read_b64_tr_b16 v[148:149], v206 offset:4096
    ds_read_b64_tr_b16 v[150:151], v206 offset:4608
    ds_read_b64_tr_b16 v[152:153], v206 offset:8192
    ds_read_b64_tr_b16 v[154:155], v206 offset:8704
    ds_read_b64_tr_b16 v[156:157], v207 offset:0
    ds_read_b64_tr_b16 v[158:159], v207 offset:512
    ds_read_b64_tr_b16 v[160:161], v207 offset:4096
    ds_read_b64_tr_b16 v[162:163], v207 offset:4608
    ds_read_b64_tr_b16 v[164:165], v207 offset:8192
    ds_read_b64_tr_b16 v[166:167], v207 offset:8704
    s_setprio 1
    v_pk_fma_f32 v[120:121], v[120:121], s[48:49], s[48:49]
    v_pk_fma_f32 v[122:123], v[122:123], s[48:49], s[48:49]
    v_pk_fma_f32 v[124:125], v[124:125], s[48:49], s[48:49]
    v_pk_fma_f32 v[126:127], v[126:127], s[48:49], s[48:49]
    v_mfma_f32_16x16x32_bf16 v[0:3], v[168:171], v[136:139], v[0:3]
    v_rcp_f32 v120, v120
    v_rcp_f32 v121, v121
    v_mfma_f32_16x16x32_bf16 v[4:7], v[172:175], v[136:139], v[4:7]
    v_rcp_f32 v122, v122
    v_rcp_f32 v123, v123
    v_mfma_f32_16x16x32_bf16 v[8:11], v[176:179], v[136:139], v[8:11]
    v_rcp_f32 v124, v124
    v_mfma_f32_16x16x32_bf16 v[12:15], v[180:183], v[136:139], v[12:15]
    v_rcp_f32 v125, v125
    v_mfma_f32_16x16x32_bf16 v[16:19], v[184:187], v[136:139], v[16:19]
    v_rcp_f32 v126, v126
    v_mfma_f32_16x16x32_bf16 v[20:23], v[188:191], v[136:139], v[20:23]
    s_waitcnt lgkmcnt(0)
    v_rcp_f32 v127, v127
    s_setprio 0
    ds_read_b64_tr_b16 v[168:169], v218 offset:49152
    ds_read_b64_tr_b16 v[170:171], v218 offset:52224
    ds_read_b64_tr_b16 v[172:173], v219 offset:49152
    ds_read_b64_tr_b16 v[174:175], v219 offset:52224
    ds_read_b64_tr_b16 v[176:177], v218 offset:49216
    ds_read_b64_tr_b16 v[178:179], v218 offset:52288
    ds_read_b64_tr_b16 v[180:181], v219 offset:49216
    ds_read_b64_tr_b16 v[182:183], v219 offset:52288
    ds_read_b64_tr_b16 v[184:185], v218 offset:49280
    ds_read_b64_tr_b16 v[186:187], v218 offset:52352
    ds_read_b64_tr_b16 v[188:189], v219 offset:49280
    ds_read_b64_tr_b16 v[190:191], v219 offset:52352
    s_setprio 0
    v_pk_mul_f32 v[120:121], v[88:89], v[120:121]
    v_pk_mul_f32 v[122:123], v[90:91], v[122:123]
    v_pk_mul_f32 v[124:125], v[92:93], v[124:125]
    v_pk_mul_f32 v[126:127], v[94:95], v[126:127]
    v_pk_fma_f32 v[104:105], v[72:73], v[72:73], s[50:51] neg_lo:[1,0,0] neg_hi:[1,0,0]
    v_pk_fma_f32 v[106:107], v[74:75], v[74:75], s[50:51] neg_lo:[1,0,0] neg_hi:[1,0,0]
    v_pk_fma_f32 v[108:109], v[76:77], v[76:77], s[50:51] neg_lo:[1,0,0] neg_hi:[1,0,0]
    v_pk_fma_f32 v[110:111], v[78:79], v[78:79], s[50:51] neg_lo:[1,0,0] neg_hi:[1,0,0]
    v_pk_fma_f32 v[112:113], v[80:81], v[80:81], s[50:51] neg_lo:[1,0,0] neg_hi:[1,0,0]
    v_pk_fma_f32 v[114:115], v[82:83], v[82:83], s[50:51] neg_lo:[1,0,0] neg_hi:[1,0,0]
    v_pk_fma_f32 v[116:117], v[84:85], v[84:85], s[50:51] neg_lo:[1,0,0] neg_hi:[1,0,0]
    v_pk_fma_f32 v[118:119], v[86:87], v[86:87], s[50:51] neg_lo:[1,0,0] neg_hi:[1,0,0]
    v_pk_mul_f32 v[104:105], v[72:73], v[104:105]
    v_pk_mul_f32 v[106:107], v[74:75], v[106:107]
    v_pk_mul_f32 v[108:109], v[76:77], v[108:109]
    v_pk_mul_f32 v[110:111], v[78:79], v[110:111]
    v_pk_mul_f32 v[112:113], v[80:81], v[112:113]
    v_pk_mul_f32 v[114:115], v[82:83], v[114:115]
    v_pk_mul_f32 v[116:117], v[84:85], v[116:117]
    v_pk_mul_f32 v[118:119], v[86:87], v[118:119]
    v_add_u32 v212, 98304, v212
    v_add_u32 v213, 98304, v213
    v_add_u32 v214, 98304, v214
    v_add_u32 v215, 98304, v215
    v_add_u32 v216, 98304, v216
    v_add_u32 v217, 98304, v217
    v_add_u32 v218, 98304, v218
    v_add_u32 v219, 98304, v219
    v_mfma_f32_16x16x32_bf16 v[88:91], v[144:147], v[48:51], 0
    v_cvt_pk_bf16_f32 v136, v120, v121
    v_cvt_pk_bf16_f32 v137, v122, v123
    v_cvt_pk_bf16_f32 v138, v124, v125
    v_cvt_pk_bf16_f32 v139, v126, v127
    v_mfma_f32_16x16x32_bf16 v[92:95], v[156:159], v[48:51], 0
    v_exp_f32 v104, v104
    v_exp_f32 v105, v105
    v_exp_f32 v106, v106
    v_exp_f32 v107, v107
    v_mfma_f32_16x16x32_bf16 v[88:91], v[148:151], v[52:55], v[88:91]
    v_exp_f32 v108, v108
    v_exp_f32 v109, v109
    v_exp_f32 v110, v110
    v_mfma_f32_16x16x32_bf16 v[92:95], v[160:163], v[52:55], v[92:95]
    v_exp_f32 v111, v111
    v_exp_f32 v112, v112
    v_exp_f32 v113, v113
    v_mfma_f32_16x16x32_bf16 v[88:91], v[152:155], v[56:59], v[88:91]
    v_exp_f32 v114, v114
    v_exp_f32 v115, v115
    v_exp_f32 v116, v116
    v_mfma_f32_16x16x32_bf16 v[92:95], v[164:167], v[56:59], v[92:95]
    s_waitcnt lgkmcnt(0)
    v_exp_f32 v117, v117
    v_exp_f32 v118, v118
    v_exp_f32 v119, v119
    s_setprio 0
    ds_read_b64_tr_b16 v[144:145], v208 offset:0
    ds_read_b64_tr_b16 v[146:147], v208 offset:512
    ds_read_b64_tr_b16 v[148:149], v208 offset:4096
    ds_read_b64_tr_b16 v[150:151], v208 offset:4608
    ds_read_b64_tr_b16 v[152:153], v208 offset:8192
    ds_read_b64_tr_b16 v[154:155], v208 offset:8704
    ds_read_b64_tr_b16 v[156:157], v209 offset:0
    ds_read_b64_tr_b16 v[158:159], v209 offset:512
    ds_read_b64_tr_b16 v[160:161], v209 offset:4096
    ds_read_b64_tr_b16 v[162:163], v209 offset:4608
    ds_read_b64_tr_b16 v[164:165], v209 offset:8192
    ds_read_b64_tr_b16 v[166:167], v209 offset:8704
    s_setprio 0
    v_pk_fma_f32 v[104:105], v[104:105], s[48:49], s[48:49]
    v_pk_fma_f32 v[106:107], v[106:107], s[48:49], s[48:49]
    v_pk_fma_f32 v[108:109], v[108:109], s[48:49], s[48:49]
    v_pk_fma_f32 v[110:111], v[110:111], s[48:49], s[48:49]
    v_pk_fma_f32 v[112:113], v[112:113], s[48:49], s[48:49]
    v_pk_fma_f32 v[114:115], v[114:115], s[48:49], s[48:49]
    v_pk_fma_f32 v[116:117], v[116:117], s[48:49], s[48:49]
    v_pk_fma_f32 v[118:119], v[118:119], s[48:49], s[48:49]
    v_mfma_f32_16x16x32_bf16 v[0:3], v[168:171], v[136:139], v[0:3]
    v_rcp_f32 v104, v104
    v_rcp_f32 v105, v105
    v_rcp_f32 v106, v106
    v_mfma_f32_16x16x32_bf16 v[4:7], v[172:175], v[136:139], v[4:7]
    v_rcp_f32 v107, v107
    v_rcp_f32 v108, v108
    v_rcp_f32 v109, v109
    v_mfma_f32_16x16x32_bf16 v[8:11], v[176:179], v[136:139], v[8:11]
    v_rcp_f32 v110, v110
    v_rcp_f32 v111, v111
    v_rcp_f32 v112, v112
    v_mfma_f32_16x16x32_bf16 v[12:15], v[180:183], v[136:139], v[12:15]
    v_rcp_f32 v113, v113
    v_rcp_f32 v114, v114
    v_rcp_f32 v115, v115
    v_mfma_f32_16x16x32_bf16 v[16:19], v[184:187], v[136:139], v[16:19]
    v_rcp_f32 v116, v116
    v_rcp_f32 v117, v117
    v_mfma_f32_16x16x32_bf16 v[20:23], v[188:191], v[136:139], v[20:23]
    s_waitcnt lgkmcnt(0)
    v_rcp_f32 v118, v118
    v_rcp_f32 v119, v119
    s_setprio 0
    ds_read_b64_tr_b16 v[168:169], v212 offset:0
    ds_read_b64_tr_b16 v[170:171], v212 offset:3072
    ds_read_b64_tr_b16 v[172:173], v213 offset:0
    ds_read_b64_tr_b16 v[174:175], v213 offset:3072
    ds_read_b64_tr_b16 v[176:177], v212 offset:64
    ds_read_b64_tr_b16 v[178:179], v212 offset:3136
    ds_read_b64_tr_b16 v[180:181], v213 offset:64
    ds_read_b64_tr_b16 v[182:183], v213 offset:3136
    ds_read_b64_tr_b16 v[184:185], v212 offset:128
    ds_read_b64_tr_b16 v[186:187], v212 offset:3200
    ds_read_b64_tr_b16 v[188:189], v213 offset:128
    ds_read_b64_tr_b16 v[190:191], v213 offset:3200
    s_cmp_lg_u32 s3, 1
    s_cbranch_scc1 L_nb
    s_setprio 1
L_nb:
    v_pk_mul_f32 v[104:105], v[72:73], v[104:105]
    v_pk_mul_f32 v[106:107], v[74:75], v[106:107]
    v_pk_mul_f32 v[108:109], v[76:77], v[108:109]
    v_pk_mul_f32 v[110:111], v[78:79], v[110:111]
    v_pk_mul_f32 v[112:113], v[80:81], v[112:113]
    v_pk_mul_f32 v[114:115], v[82:83], v[114:115]
    v_pk_mul_f32 v[116:117], v[84:85], v[116:117]
    v_pk_mul_f32 v[118:119], v[86:87], v[118:119]
    v_pk_fma_f32 v[120:121], v[88:89], v[88:89], s[50:51] neg_lo:[1,0,0] neg_hi:[1,0,0]
    v_pk_fma_f32 v[122:123], v[90:91], v[90:91], s[50:51] neg_lo:[1,0,0] neg_hi:[1,0,0]
    v_pk_fma_f32 v[124:125], v[92:93], v[92:93], s[50:51] neg_lo:[1,0,0] neg_hi:[1,0,0]
    v_pk_fma_f32 v[126:127], v[94:95], v[94:95], s[50:51] neg_lo:[1,0,0] neg_hi:[1,0,0]
    v_pk_mul_f32 v[120:121], v[88:89], v[120:121]
    v_pk_mul_f32 v[122:123], v[90:91], v[122:123]
    v_pk_mul_f32 v[124:125], v[92:93], v[124:125]
    v_pk_mul_f32 v[126:127], v[94:95], v[126:127]
    v_mfma_f32_16x16x32_bf16 v[72:75], v[144:147], v[48:51], 0
    v_cvt_pk_bf16_f32 v136, v104, v105
    v_cvt_pk_bf16_f32 v137, v106, v107
    v_cvt_pk_bf16_f32 v138, v108, v109
    v_mfma_f32_16x16x32_bf16 v[76:79], v[156:159], v[48:51], 0
    v_cvt_pk_bf16_f32 v139, v110, v111
    v_cvt_pk_bf16_f32 v140, v112, v113
    v_cvt_pk_bf16_f32 v141, v114, v115
    v_mfma_f32_16x16x32_bf16 v[72:75], v[148:151], v[52:55], v[72:75]
    v_cvt_pk_bf16_f32 v142, v116, v117
    v_cvt_pk_bf16_f32 v143, v118, v119
    v_exp_f32 v120, v120
    v_mfma_f32_16x16x32_bf16 v[76:79], v[160:163], v[52:55], v[76:79]
    v_exp_f32 v121, v121
    v_exp_f32 v122, v122
    v_exp_f32 v123, v123
    v_mfma_f32_16x16x32_bf16 v[72:75], v[152:155], v[56:59], v[72:75]
    v_exp_f32 v124, v124
    v_exp_f32 v125, v125
    v_mfma_f32_16x16x32_bf16 v[76:79], v[164:167], v[56:59], v[76:79]
    s_waitcnt lgkmcnt(0)
    v_exp_f32 v126, v126
    v_exp_f32 v127, v127
    ds_read_b64_tr_b16 v[144:145], v210 offset:0
    ds_read_b64_tr_b16 v[146:147], v210 offset:512
    ds_read_b64_tr_b16 v[148:149], v210 offset:4096
    ds_read_b64_tr_b16 v[150:151], v210 offset:4608
    ds_read_b64_tr_b16 v[152:153], v210 offset:8192
    ds_read_b64_tr_b16 v[154:155], v210 offset:8704
    ds_read_b64_tr_b16 v[156:157], v211 offset:0
    ds_read_b64_tr_b16 v[158:159], v211 offset:512
    ds_read_b64_tr_b16 v[160:161], v211 offset:4096
    ds_read_b64_tr_b16 v[162:163], v211 offset:4608
    ds_read_b64_tr_b16 v[164:165], v211 offset:8192
    ds_read_b64_tr_b16 v[166:167], v211 offset:8704
    v_pk_fma_f32 v[120:121], v[120:121], s[48:49], s[48:49]
    v_pk_fma_f32 v[122:123], v[122:123], s[48:49], s[48:49]
    v_pk_fma_f32 v[124:125], v[124:125], s[48:49], s[48:49]
    v_pk_fma_f32 v[126:127], v[126:127], s[48:49], s[48:49]
    v_mfma_f32_16x16x32_bf16 v[0:3], v[168:171], v[136:139], v[0:3]
    v_rcp_f32 v120, v120
    v_mfma_f32_16x16x32_bf16 v[4:7], v[172:175], v[136:139], v[4:7]
    v_rcp_f32 v121, v121
    v_mfma_f32_16x16x32_bf16 v[8:11], v[176:179], v[136:139], v[8:11]
    v_rcp_f32 v122, v122
    v_mfma_f32_16x16x32_bf16 v[12:15], v[180:183], v[136:139], v[12:15]
    v_rcp_f32 v123, v123
    v_mfma_f32_16x16x32_bf16 v[16:19], v[184:187], v[136:139], v[16:19]
    v_rcp_f32 v124, v124
    v_mfma_f32_16x16x32_bf16 v[20:23], v[188:191], v[136:139], v[20:23]
    v_rcp_f32 v125, v125
    v_mfma_f32_16x16x32_bf16 v[24:27], v[168:171], v[140:143], v[24:27]
    v_rcp_f32 v126, v126
    v_mfma_f32_16x16x32_bf16 v[28:31], v[172:175], v[140:143], v[28:31]
    v_rcp_f32 v127, v127
    v_mfma_f32_16x16x32_bf16 v[32:35], v[176:179], v[140:143], v[32:35]
    v_mfma_f32_16x16x32_bf16 v[36:39], v[180:183], v[140:143], v[36:39]
    v_mfma_f32_16x16x32_bf16 v[40:43], v[184:187], v[140:143], v[40:43]
    v_mfma_f32_16x16x32_bf16 v[44:47], v[188:191], v[140:143], v[44:47]
    s_waitcnt lgkmcnt(0)
    ds_read_b64_tr_b16 v[168:169], v214 offset:0
    ds_read_b64_tr_b16 v[170:171], v214 offset:3072
    ds_read_b64_tr_b16 v[172:173], v215 offset:0
    ds_read_b64_tr_b16 v[174:175], v215 offset:3072
    ds_read_b64_tr_b16 v[176:177], v214 offset:64
    ds_read_b64_tr_b16 v[178:179], v214 offset:3136
    ds_read_b64_tr_b16 v[180:181], v215 offset:64
    ds_read_b64_tr_b16 v[182:183], v215 offset:3136
    ds_read_b64_tr_b16 v[184:185], v214 offset:128
    ds_read_b64_tr_b16 v[186:187], v214 offset:3200
    ds_read_b64_tr_b16 v[188:189], v215 offset:128
    ds_read_b64_tr_b16 v[190:191], v215 offset:3200
    ds_read_b32 v249, v243 offset:0
    v_pk_mul_f32 v[120:121], v[88:89], v[120:121]
    v_pk_mul_f32 v[122:123], v[90:91], v[122:123]
    v_pk_mul_f32 v[124:125], v[92:93], v[124:125]
    v_pk_mul_f32 v[126:127], v[94:95], v[126:127]
    v_pk_fma_f32 v[104:105], v[72:73], v[72:73], s[50:51] neg_lo:[1,0,0] neg_hi:[1,0,0]
    v_pk_fma_f32 v[106:107], v[74:75], v[74:75], s[50:51] neg_lo:[1,0,0] neg_hi:[1,0,0]
    v_pk_fma_f32 v[108:109], v[76:77], v[76:77], s[50:51] neg_lo:[1,0,0] neg_hi:[1,0,0]
    v_pk_fma_f32 v[110:111], v[78:79], v[78:79], s[50:51] neg_lo:[1,0,0] neg_hi:[1,0,0]
    v_pk_mul_f32 v[104:105], v[72:73], v[104:105]
    v_pk_mul_f32 v[106:107], v[74:75], v[106:107]
    v_pk_mul_f32 v[108:109], v[76:77], v[108:109]
    v_pk_mul_f32 v[110:111], v[78:79], v[110:111]
    v_mfma_f32_16x16x32_bf16 v[88:91], v[144:147], v[48:51], 0
    v_cvt_pk_bf16_f32 v136, v120, v121
    v_cvt_pk_bf16_f32 v137, v122, v123
    v_mfma_f32_16x16x32_bf16 v[92:95], v[156:159], v[48:51], 0
    v_cvt_pk_bf16_f32 v138, v124, v125
    v_cvt_pk_bf16_f32 v139, v126, v127
    v_mfma_f32_16x16x32_bf16 v[88:91], v[148:151], v[52:55], v[88:91]
    v_exp_f32 v104, v104
    v_exp_f32 v105, v105
    v_mfma_f32_16x16x32_bf16 v[92:95], v[160:163], v[52:55], v[92:95]
    v_exp_f32 v106, v106
    v_exp_f32 v107, v107
    v_mfma_f32_16x16x32_bf16 v[88:91], v[152:155], v[56:59], v[88:91]
    v_exp_f32 v108, v108
    v_exp_f32 v109, v109
    v_mfma_f32_16x16x32_bf16 v[92:95], v[164:167], v[56:59], v[92:95]
    s_waitcnt lgkmcnt(0)
    v_exp_f32 v110, v110
    v_exp_f32 v111, v111
    v_cmp_gt_u32 vcc, 4, v249
    s_cbranch_vccnz L_slow15
L_back15:
    s_cmp_eq_u32 s3, 1
    s_cbranch_scc1 L_np
    s_mul_i32 s43, s3, 6144
    v_add_u32 v250, s43, v244
    ds_write_b128 v250, v[24:27] offset:24576
    ds_write_b128 v250, v[28:31] offset:25600
    ds_write_b128 v250, v[32:35] offset:26624
    ds_write_b128 v250, v[36:39] offset:27648
    ds_write_b128 v250, v[40:43] offset:28672
    ds_write_b128 v250, v[44:47] offset:29696
L_np:
    v_mov_b32 v254, 9
    ds_write_b32 v248, v254
    v_pk_fma_f32 v[104:105], v[104:105], s[48:49], s[48:49]
    v_pk_fma_f32 v[106:107], v[106:107], s[48:49], s[48:49]
    v_pk_fma_f32 v[108:109], v[108:109], s[48:49], s[48:49]
    v_pk_fma_f32 v[110:111], v[110:111], s[48:49], s[48:49]
    v_mfma_f32_16x16x32_bf16 v[0:3], v[168:171], v[136:139], v[0:3]
    v_rcp_f32 v104, v104
    v_rcp_f32 v105, v105
    v_mfma_f32_16x16x32_bf16 v[4:7], v[172:175], v[136:139], v[4:7]
    v_rcp_f32 v106, v106
    v_rcp_f32 v107, v107
    v_mfma_f32_16x16x32_bf16 v[8:11], v[176:179], v[136:139], v[8:11]
    v_rcp_f32 v108, v108
    v_mfma_f32_16x16x32_bf16 v[12:15], v[180:183], v[136:139], v[12:15]
    v_rcp_f32 v109, v109
    v_mfma_f32_16x16x32_bf16 v[16:19], v[184:187], v[136:139], v[16:19]
    v_rcp_f32 v110, v110
    v_mfma_f32_16x16x32_bf16 v[20:23], v[188:191], v[136:139], v[20:23]
    s_waitcnt lgkmcnt(0)
    v_rcp_f32 v111, v111
    ds_read_b64_tr_b16 v[168:169], v216 offset:0
    ds_read_b64_tr_b16 v[170:171], v216 offset:3072
    ds_read_b64_tr_b16 v[172:173], v217 offset:0
    ds_read_b64_tr_b16 v[174:175], v217 offset:3072
    ds_read_b64_tr_b16 v[176:177], v216 offset:64
    ds_read_b64_tr_b16 v[178:179], v216 offset:3136
    ds_read_b64_tr_b16 v[180:181], v217 offset:64
    ds_read_b64_tr_b16 v[182:183], v217 offset:3136
    ds_read_b64_tr_b16 v[184:185], v216 offset:128
    ds_read_b64_tr_b16 v[186:187], v216 offset:3200
    ds_read_b64_tr_b16 v[188:189], v217 offset:128
    ds_read_b64_tr_b16 v[190:191], v217 offset:3200
    v_pk_mul_f32 v[104:105], v[72:73], v[104:105]
    v_pk_mul_f32 v[106:107], v[74:75], v[106:107]
    v_pk_mul_f32 v[108:109], v[76:77], v[108:109]
    v_pk_mul_f32 v[110:111], v[78:79], v[110:111]
    v_pk_fma_f32 v[120:121], v[88:89], v[88:89], s[50:51] neg_lo:[1,0,0] neg_hi:[1,0,0]
    v_pk_fma_f32 v[122:123], v[90:91], v[90:91], s[50:51] neg_lo:[1,0,0] neg_hi:[1,0,0]
    v_pk_fma_f32 v[124:125], v[92:93], v[92:93], s[50:51] neg_lo:[1,0,0] neg_hi:[1,0,0]
    v_pk_fma_f32 v[126:127], v[94:95], v[94:95], s[50:51] neg_lo:[1,0,0] neg_hi:[1,0,0]
    v_pk_mul_f32 v[120:121], v[88:89], v[120:121]
    v_pk_mul_f32 v[122:123], v[90:91], v[122:123]
    v_pk_mul_f32 v[124:125], v[92:93], v[124:125]
    v_pk_mul_f32 v[126:127], v[94:95], v[126:127]
    v_cvt_pk_bf16_f32 v136, v104, v105
    v_cvt_pk_bf16_f32 v137, v106, v107
    v_cvt_pk_bf16_f32 v138, v108, v109
    v_cvt_pk_bf16_f32 v139, v110, v111
    v_exp_f32 v120, v120
    v_exp_f32 v121, v121
    v_exp_f32 v122, v122
    v_exp_f32 v123, v123
    v_exp_f32 v124, v124
    v_exp_f32 v125, v125
    v_exp_f32 v126, v126
    v_exp_f32 v127, v127
    s_waitcnt lgkmcnt(0)
    s_cmp_lg_u32 s3, 1
    s_cbranch_scc1 L_nored
L_poll16:
    ds_read_b32 v249, v243 offset:16
    s_waitcnt lgkmcnt(0)
    v_cmp_gt_u32 vcc, 9, v249
    s_cbranch_vccnz L_poll16
    ds_read_b128 v[144:147], v244 offset:24576
    ds_read_b128 v[148:151], v244 offset:25600
    ds_read_b128 v[152:155], v244 offset:26624
    ds_read_b128 v[156:159], v244 offset:27648
    ds_read_b128 v[160:163], v244 offset:28672
    ds_read_b128 v[164:167], v244 offset:29696
    ds_read_b128 v[48:51], v244 offset:36864
    ds_read_b128 v[52:55], v244 offset:37888
    ds_read_b128 v[56:59], v244 offset:38912
    ds_read_b128 v[60:63], v244 offset:39936
    ds_read_b128 v[64:67], v244 offset:40960
    ds_read_b128 v[68:71], v244 offset:41984
    s_waitcnt lgkmcnt(6)
    v_add_f32 v24, v24, v144
    v_add_f32 v25, v25, v145
    v_add_f32 v26, v26, v146
    v_add_f32 v27, v27, v147
    v_add_f32 v28, v28, v148
    v_add_f32 v29, v29, v149
    v_add_f32 v30, v30, v150
    v_add_f32 v31, v31, v151
    v_add_f32 v32, v32, v152
    v_add_f32 v33, v33, v153
    v_add_f32 v34, v34, v154
    v_add_f32 v35, v35, v155
    v_add_f32 v36, v36, v156
    v_add_f32 v37, v37, v157
    v_add_f32 v38, v38, v158
    v_add_f32 v39, v39, v159
    v_add_f32 v40, v40, v160
    v_add_f32 v41, v41, v161
    v_add_f32 v42, v42, v162
    v_add_f32 v43, v43, v163
    v_add_f32 v44, v44, v164
    v_add_f32 v45, v45, v165
    v_add_f32 v46, v46, v166
    v_add_f32 v47, v47, v167
    ds_read_b128 v[144:147], v244 offset:43008
    ds_read_b128 v[148:151], v244 offset:44032
    ds_read_b128 v[152:155], v244 offset:45056
    ds_read_b128 v[156:159], v244 offset:46080
    ds_read_b128 v[160:163], v244 offset:47104
    ds_read_b128 v[164:167], v244 offset:48128
    s_waitcnt lgkmcnt(6)
    v_add_f32 v24, v24, v48
    v_add_f32 v25, v25, v49
    v_add_f32 v26, v26, v50
    v_add_f32 v27, v27, v51
    v_add_f32 v28, v28, v52
    v_add_f32 v29, v29, v53
    v_add_f32 v30, v30, v54
    v_add_f32 v31, v31, v55
    v_add_f32 v32, v32, v56
    v_add_f32 v33, v33, v57
    v_add_f32 v34, v34, v58
    v_add_f32 v35, v35, v59
    v_add_f32 v36, v36, v60
    v_add_f32 v37, v37, v61
    v_add_f32 v38, v38, v62
    v_add_f32 v39, v39, v63
    v_add_f32 v40, v40, v64
    v_add_f32 v41, v41, v65
    v_add_f32 v42, v42, v66
    v_add_f32 v43, v43, v67
    v_add_f32 v44, v44, v68
    v_add_f32 v45, v45, v69
    v_add_f32 v46, v46, v70
    v_add_f32 v47, v47, v71
    s_waitcnt lgkmcnt(0)
    v_add_f32 v24, v24, v144
    v_add_f32 v25, v25, v145
    v_add_f32 v26, v26, v146
    v_add_f32 v27, v27, v147
    v_add_f32 v28, v28, v148
    v_add_f32 v29, v29, v149
    v_add_f32 v30, v30, v150
    v_add_f32 v31, v31, v151
    v_add_f32 v32, v32, v152
    v_add_f32 v33, v33, v153
    v_add_f32 v34, v34, v154
    v_add_f32 v35, v35, v155
    v_add_f32 v36, v36, v156
    v_add_f32 v37, v37, v157
    v_add_f32 v38, v38, v158
    v_add_f32 v39, v39, v159
    v_add_f32 v40, v40, v160
    v_add_f32 v41, v41, v161
    v_add_f32 v42, v42, v162
    v_add_f32 v43, v43, v163
    v_add_f32 v44, v44, v164
    v_add_f32 v45, v45, v165
    v_add_f32 v46, v46, v166
    v_add_f32 v47, v47, v167
    s_add_u32 s61, s60, 129024
    v_cvt_pk_bf16_f32 v48, v24, v25
    v_cvt_pk_bf16_f32 v49, v26, v27
    v_cvt_pk_bf16_f32 v50, v28, v29
    v_cvt_pk_bf16_f32 v51, v30, v31
    v_cvt_pk_bf16_f32 v52, v32, v33
    v_cvt_pk_bf16_f32 v53, v34, v35
    v_cvt_pk_bf16_f32 v54, v36, v37
    v_cvt_pk_bf16_f32 v55, v38, v39
    v_cvt_pk_bf16_f32 v56, v40, v41
    v_cvt_pk_bf16_f32 v57, v42, v43
    v_cvt_pk_bf16_f32 v58, v44, v45
    v_cvt_pk_bf16_f32 v59, v46, v47
    ds_write_b64 v246, v[48:49] offset:0
    ds_write_b64 v247, v[50:51] offset:0
    ds_write_b64 v246, v[52:53] offset:64
    ds_write_b64 v247, v[54:55] offset:64
    ds_write_b64 v246, v[56:57] offset:128
    ds_write_b64 v247, v[58:59] offset:128
    ds_read_b128 v[144:147], v240
    ds_read_b128 v[148:151], v241
    ds_read_b128 v[152:155], v242
    s_waitcnt lgkmcnt(2)
    buffer_store_dwordx4 v[144:147], v244, s[36:39], s61 offen offset:0 sc1
    s_waitcnt lgkmcnt(1)
    buffer_store_dwordx4 v[148:151], v244, s[36:39], s61 offen offset:1024 sc1
    s_waitcnt lgkmcnt(0)
    buffer_store_dwordx4 v[152:155], v244, s[36:39], s61 offen offset:2048 sc1
L_nored:
    v_pk_fma_f32 v[120:121], v[120:121], s[48:49], s[48:49]
    v_pk_fma_f32 v[122:123], v[122:123], s[48:49], s[48:49]
    v_pk_fma_f32 v[124:125], v[124:125], s[48:49], s[48:49]
    v_pk_fma_f32 v[126:127], v[126:127], s[48:49], s[48:49]
    v_mfma_f32_16x16x32_bf16 v[0:3], v[168:171], v[136:139], v[0:3]
    v_rcp_f32 v120, v120
    v_rcp_f32 v121, v121
    v_mfma_f32_16x16x32_bf16 v[4:7], v[172:175], v[136:139], v[4:7]
    v_rcp_f32 v122, v122
    v_rcp_f32 v123, v123
    v_mfma_f32_16x16x32_bf16 v[8:11], v[176:179], v[136:139], v[8:11]
    v_rcp_f32 v124, v124
    v_mfma_f32_16x16x32_bf16 v[12:15], v[180:183], v[136:139], v[12:15]
    v_rcp_f32 v125, v125
    v_mfma_f32_16x16x32_bf16 v[16:19], v[184:187], v[136:139], v[16:19]
    v_rcp_f32 v126, v126
    v_mfma_f32_16x16x32_bf16 v[20:23], v[188:191], v[136:139], v[20:23]
    s_waitcnt lgkmcnt(0)
    v_rcp_f32 v127, v127
    ds_read_b64_tr_b16 v[168:169], v218 offset:0
    ds_read_b64_tr_b16 v[170:171], v218 offset:3072
    ds_read_b64_tr_b16 v[172:173], v219 offset:0
    ds_read_b64_tr_b16 v[174:175], v219 offset:3072
    ds_read_b64_tr_b16 v[176:177], v218 offset:64
    ds_read_b64_tr_b16 v[178:179], v218 offset:3136
    ds_read_b64_tr_b16 v[180:181], v219 offset:64
    ds_read_b64_tr_b16 v[182:183], v219 offset:3136
    ds_read_b64_tr_b16 v[184:185], v218 offset:128
    ds_read_b64_tr_b16 v[186:187], v218 offset:3200
    ds_read_b64_tr_b16 v[188:189], v219 offset:128
    ds_read_b64_tr_b16 v[190:191], v219 offset:3200
    v_pk_mul_f32 v[120:121], v[88:89], v[120:121]
    v_pk_mul_f32 v[122:123], v[90:91], v[122:123]
    v_pk_mul_f32 v[124:125], v[92:93], v[124:125]
    v_pk_mul_f32 v[126:127], v[94:95], v[126:127]
    v_cvt_pk_bf16_f32 v136, v120, v121
    v_cvt_pk_bf16_f32 v137, v122, v123
    v_cvt_pk_bf16_f32 v138, v124, v125
    v_cvt_pk_bf16_f32 v139, v126, v127
    s_waitcnt lgkmcnt(0)
    s_nop 0
    v_mfma_f32_16x16x32_bf16 v[0:3], v[168:171], v[136:139], v[0:3]
    v_mfma_f32_16x16x32_bf16 v[4:7], v[172:175], v[136:139], v[4:7]
    v_mfma_f32_16x16x32_bf16 v[8:11], v[176:179], v[136:139], v[8:11]
    v_mfma_f32_16x16x32_bf16 v[12:15], v[180:183], v[136:139], v[12:15]
    v_mfma_f32_16x16x32_bf16 v[16:19], v[184:187], v[136:139], v[16:19]
    v_mfma_f32_16x16x32_bf16 v[20:23], v[188:191], v[136:139], v[20:23]
    s_nop 2
    v_cvt_pk_bf16_f32 v72, v0, v1
    v_cvt_pk_bf16_f32 v73, v2, v3
    v_cvt_pk_bf16_f32 v74, v4, v5
    v_cvt_pk_bf16_f32 v75, v6, v7
    v_cvt_pk_bf16_f32 v76, v8, v9
    v_cvt_pk_bf16_f32 v77, v10, v11
    v_cvt_pk_bf16_f32 v78, v12, v13
    v_cvt_pk_bf16_f32 v79, v14, v15
    v_cvt_pk_bf16_f32 v80, v16, v17
    v_cvt_pk_bf16_f32 v81, v18, v19
    v_cvt_pk_bf16_f32 v82, v20, v21
    v_cvt_pk_bf16_f32 v83, v22, v23
    ds_write_b64 v246, v[72:73] offset:0
    ds_write_b64 v247, v[74:75] offset:0
    ds_write_b64 v246, v[76:77] offset:64
    ds_write_b64 v247, v[78:79] offset:64
    ds_write_b64 v246, v[80:81] offset:128
    ds_write_b64 v247, v[82:83] offset:128
    ds_read_b128 v[104:107], v240
    ds_read_b128 v[108:111], v241
    ds_read_b128 v[112:115], v242
    s_waitcnt lgkmcnt(2)
    buffer_store_dwordx4 v[104:107], v244, s[36:39], s60 offen offset:0 sc1
    s_waitcnt lgkmcnt(1)
    buffer_store_dwordx4 v[108:111], v244, s[36:39], s60 offen offset:1024 sc1
    s_waitcnt lgkmcnt(0)
    buffer_store_dwordx4 v[112:115], v244, s[36:39], s60 offen offset:2048 sc1
    s_endpgm
L_slow8:
    ds_read_b32 v249, v243 offset:0
    s_waitcnt lgkmcnt(0)
    v_cmp_gt_u32 vcc, 2, v249
    s_cbranch_vccnz L_slow8
    s_branch L_back8
L_slow9:
    ds_read_b32 v249, v243 offset:16
    s_waitcnt lgkmcnt(0)
    v_cmp_gt_u32 vcc, 3, v249
    s_cbranch_vccnz L_slow9
    s_branch L_back9
L_slow10:
    ds_read_b32 v249, v243 offset:0
    s_waitcnt lgkmcnt(0)
    v_cmp_gt_u32 vcc, 3, v249
    s_cbranch_vccnz L_slow10
    s_branch L_back10
L_slow11:
    ds_read_b32 v249, v243 offset:16
    s_waitcnt lgkmcnt(0)
    v_cmp_gt_u32 vcc, 5, v249
    s_cbranch_vccnz L_slow11
    s_branch L_back11
L_slow12:
    ds_read_b32 v249, v243 offset:16
    s_waitcnt lgkmcnt(0)
    v_cmp_gt_u32 vcc, 6, v249
    s_cbranch_vccnz L_slow12
    s_branch L_back12
L_slow13:
    ds_read_b32 v249, v243 offset:16
    s_waitcnt lgkmcnt(0)
    v_cmp_gt_u32 vcc, 7, v249
    s_cbranch_vccnz L_slow13
    s_branch L_back13
L_slow14:
    ds_read_b32 v249, v243 offset:16
    s_waitcnt lgkmcnt(0)
    v_cmp_gt_u32 vcc, 8, v249
    s_cbranch_vccnz L_slow14
    s_branch L_back14
L_slow15:
    ds_read_b32 v249, v243 offset:0
    s_waitcnt lgkmcnt(0)
    v_cmp_gt_u32 vcc, 4, v249
    s_cbranch_vccnz L_slow15
    s_branch L_back15
L_L12:
    ds_read_b128 v[144:147], v192 offset:30720
    ds_read_b128 v[148:151], v192 offset:34560
    ds_read_b128 v[152:155], v192 offset:38400
    ds_read_b128 v[156:159], v192 offset:42240
    ds_read_b128 v[160:163], v192 offset:46080
    ds_read_b128 v[164:167], v192 offset:49920
    ds_read_b128 v[168:171], v192 offset:53760
    ds_read_b128 v[172:175], v192 offset:57600
    ds_read_b128 v[60:63], v193 offset:30720
    ds_read_b128 v[64:67], v193 offset:46080
    s_waitcnt lgkmcnt(8)
    v_smfmac_f32_16x16x64_bf16 v[0:3], v[84:87], v[144:151], v199
    ds_read_b128 v[176:179], v192 offset:30784
    ds_read_b128 v[180:183], v192 offset:34624
    s_waitcnt lgkmcnt(8)
    v_smfmac_f32_16x16x64_bf16 v[0:3], v[88:91], v[152:159], v199
    ds_read_b128 v[184:187], v192 offset:38464
    v_smfmac_f32_16x16x64_bf16 v[4:7], v[84:87], v[152:159], v199
    ds_read_b128 v[188:191], v192 offset:42304
    s_waitcnt lgkmcnt(8)
    v_smfmac_f32_16x16x64_bf16 v[0:3], v[92:95], v[160:167], v199
    ds_read_b128 v[144:147], v192 offset:46144
    v_smfmac_f32_16x16x64_bf16 v[4:7], v[88:91], v[160:167], v199
    ds_read_b128 v[148:151], v192 offset:49984
    s_waitcnt lgkmcnt(8)
    v_smfmac_f32_16x16x64_bf16 v[4:7], v[92:95], v[168:175], v199
    ds_read_b128 v[152:155], v192 offset:53824
    ds_read_b128 v[156:159], v192 offset:57664
    s_waitcnt lgkmcnt(8)
    v_smfmac_f32_16x16x64_bf16 v[0:3], v[96:99], v[60:67], v199
    ds_read_b128 v[72:75], v193 offset:30784
    v_smfmac_f32_16x16x64_bf16 v[4:7], v[100:103], v[60:67], v199
    ds_read_b128 v[76:79], v193 offset:46144
    s_waitcnt lgkmcnt(8)
    v_smfmac_f32_16x16x64_bf16 v[16:19], v[104:107], v[176:183], v199
    ds_read_b128 v[160:163], v192 offset:30848
    ds_read_b128 v[164:167], v192 offset:34688
    s_nop 0
    v_cvt_pk_bf16_f32 v0, v0, v1
    v_cvt_pk_bf16_f32 v1, v2, v3
    v_cvt_pk_bf16_f32 v4, v4, v5
    v_cvt_pk_bf16_f32 v5, v6, v7
    ds_write_b64 v195, v[0:1] offset:0
    ds_write_b64 v195, v[4:5] offset:6144
    s_waitcnt lgkmcnt(10)
    v_smfmac_f32_16x16x64_bf16 v[16:19], v[108:111], v[184:191], v199
    ds_read_b128 v[168:171], v192 offset:38528
    v_smfmac_f32_16x16x64_bf16 v[20:23], v[104:107], v[184:191], v199
    ds_read_b128 v[172:175], v192 offset:42368
    s_waitcnt lgkmcnt(10)
    v_smfmac_f32_16x16x64_bf16 v[16:19], v[112:115], v[144:151], v199
    ds_read_b128 v[176:179], v192 offset:46208
    v_smfmac_f32_16x16x64_bf16 v[20:23], v[108:111], v[144:151], v199
    ds_read_b128 v[180:183], v192 offset:50048
    s_waitcnt lgkmcnt(10)
    v_smfmac_f32_16x16x64_bf16 v[20:23], v[112:115], v[152:159], v199
    ds_read_b128 v[184:187], v192 offset:53888
    ds_read_b128 v[188:191], v192 offset:57728
    s_waitcnt lgkmcnt(10)
    v_smfmac_f32_16x16x64_bf16 v[16:19], v[116:119], v[72:79], v199
    ds_read_b128 v[228:231], v193 offset:30848
    v_smfmac_f32_16x16x64_bf16 v[20:23], v[120:123], v[72:79], v199
    ds_read_b128 v[232:235], v193 offset:46208
    s_waitcnt lgkmcnt(10)
    v_smfmac_f32_16x16x64_bf16 v[32:35], v[124:127], v[160:167], v199
    s_nop 2
    v_cvt_pk_bf16_f32 v16, v16, v17
    v_cvt_pk_bf16_f32 v17, v18, v19
    v_cvt_pk_bf16_f32 v20, v20, v21
    v_cvt_pk_bf16_f32 v21, v22, v23
    ds_write_b64 v195, v[16:17] offset:64
    ds_write_b64 v195, v[20:21] offset:6208
    s_waitcnt lgkmcnt(8)
    v_smfmac_f32_16x16x64_bf16 v[32:35], v[128:131], v[168:175], v199
    v_smfmac_f32_16x16x64_bf16 v[36:39], v[124:127], v[168:175], v199
    s_waitcnt lgkmcnt(6)
    v_smfmac_f32_16x16x64_bf16 v[32:35], v[132:135], v[176:183], v199
    v_smfmac_f32_16x16x64_bf16 v[36:39], v[128:131], v[176:183], v199
    s_waitcnt lgkmcnt(4)
    v_smfmac_f32_16x16x64_bf16 v[36:39], v[132:135], v[184:191], v199
    s_waitcnt lgkmcnt(2)
    v_smfmac_f32_16x16x64_bf16 v[32:35], v[136:139], v[228:235], v199
    v_smfmac_f32_16x16x64_bf16 v[36:39], v[140:143], v[228:235], v199
    s_nop 6
    v_cvt_pk_bf16_f32 v32, v32, v33
    v_cvt_pk_bf16_f32 v33, v34, v35
    v_cvt_pk_bf16_f32 v36, v36, v37
    v_cvt_pk_bf16_f32 v37, v38, v39
    ds_write_b64 v195, v[32:33] offset:128
    ds_write_b64 v195, v[36:37] offset:6272
    v_mov_b32 v254, 2
    ds_write_b32 v248, v254
    ds_read_b64 v[60:61], v200 offset:38400
    ds_read_b64 v[62:63], v201 offset:38400
    ds_read_b64 v[64:65], v200 offset:38464
    ds_read_b64 v[66:67], v201 offset:38464
    ds_read_b64 v[68:69], v200 offset:38528
    ds_read_b64 v[70:71], v201 offset:38528
L_poll17:
    ds_read_b32 v249, v243 offset:16
    s_waitcnt lgkmcnt(0)
    v_cmp_gt_u32 vcc, 2, v249
    s_cbranch_vccnz L_poll17
    ds_read_b64 v[168:169], v48 offset:0
    ds_read_b64 v[170:171], v49 offset:0
    ds_read_b64 v[172:173], v48 offset:64
    ds_read_b64 v[174:175], v49 offset:64
    ds_read_b64 v[176:177], v48 offset:128
    ds_read_b64 v[178:179], v49 offset:128
    v_lshlrev_b32 v0, 16, v60
    v_and_b32 v1, 0xffff0000, v60
    v_lshlrev_b32 v2, 16, v61
    v_and_b32 v3, 0xffff0000, v61
    v_lshlrev_b32 v4, 16, v62
    v_and_b32 v5, 0xffff0000, v62
    v_lshlrev_b32 v6, 16, v63
    v_and_b32 v7, 0xffff0000, v63
    v_lshlrev_b32 v8, 16, v64
    v_and_b32 v9, 0xffff0000, v64
    v_lshlrev_b32 v10, 16, v65
    v_and_b32 v11, 0xffff0000, v65
    v_lshlrev_b32 v12, 16, v66
    v_and_b32 v13, 0xffff0000, v66
    v_lshlrev_b32 v14, 16, v67
    v_and_b32 v15, 0xffff0000, v67
    v_lshlrev_b32 v16, 16, v68
    v_and_b32 v17, 0xffff0000, v68
    v_lshlrev_b32 v18, 16, v69
    v_and_b32 v19, 0xffff0000, v69
    v_lshlrev_b32 v20, 16, v70
    v_and_b32 v21, 0xffff0000, v70
    v_lshlrev_b32 v22, 16, v71
    v_and_b32 v23, 0xffff0000, v71
    v_mov_b32 v254, 3
    ds_write_b32 v248, v254
    s_waitcnt lgkmcnt(1)
    v_mov_b32 v254, 0x3f803f80
    v_lshlrev_b32 v72, 16, v168
    v_and_b32 v73, 0xffff0000, v168
    v_lshlrev_b32 v74, 16, v169
    v_and_b32 v75, 0xffff0000, v169
    v_lshlrev_b32 v76, 16, v170
    v_and_b32 v77, 0xffff0000, v170
    v_lshlrev_b32 v78, 16, v171
    v_and_b32 v79, 0xffff0000, v171
    v_lshlrev_b32 v80, 16, v172
    v_and_b32 v81, 0xffff0000, v172
    v_lshlrev_b32 v82, 16, v173
    v_and_b32 v83, 0xffff0000, v173
    v_lshlrev_b32 v84, 16, v174
    v_and_b32 v85, 0xffff0000, v174
    v_lshlrev_b32 v86, 16, v175
    v_and_b32 v87, 0xffff0000, v175
    v_dot2_f32_bf16 v251, v168, v254, 0
    v_dot2_f32_bf16 v253, v168, v168, 0
    v_dot2_f32_bf16 v251, v169, v254, v251
    v_dot2_f32_bf16 v253, v169, v169, v253
    v_dot2_f32_bf16 v251, v170, v254, v251
    v_dot2_f32_bf16 v253, v170, v170, v253
    v_dot2_f32_bf16 v251, v171, v254, v251
    v_dot2_f32_bf16 v253, v171, v171, v253
    v_dot2_f32_bf16 v251, v172, v254, v251
    v_dot2_f32_bf16 v253, v172, v172, v253
    v_dot2_f32_bf16 v251, v173, v254, v251
    v_dot2_f32_bf16 v253, v173, v173, v253
    v_dot2_f32_bf16 v251, v174, v254, v251
    v_dot2_f32_bf16 v253, v174, v174, v253
    v_dot2_f32_bf16 v251, v175, v254, v251
    v_dot2_f32_bf16 v253, v175, v175, v253
    v_dot2_f32_bf16 v251, v176, v254, v251
    v_dot2_f32_bf16 v253, v176, v176, v253
    v_dot2_f32_bf16 v251, v177, v254, v251
    v_dot2_f32_bf16 v253, v177, v177, v253
    v_dot2_f32_bf16 v251, v178, v254, v251
    v_dot2_f32_bf16 v253, v178, v178, v253
    v_dot2_f32_bf16 v251, v179, v254, v251
    v_dot2_f32_bf16 v253, v179, v179, v253
    v_lshlrev_b32 v88, 16, v176
    v_and_b32 v89, 0xffff0000, v176
    v_lshlrev_b32 v90, 16, v177
    v_permlane32_swap_b32 v251, v253
    v_add_f32 v251, v251, v253
    v_mov_b32 v253, v251
    v_and_b32 v91, 0xffff0000, v177
    v_lshlrev_b32 v92, 16, v178
    v_permlane16_swap_b32 v251, v253
    v_add_f32 v251, v251, v253
    v_mul_f32 v251, 0x3c2aaaab, v251
    v_mov_b32 v253, v251
    v_and_b32 v93, 0xffff0000, v178
    v_lshlrev_b32 v94, 16, v179
    v_permlane32_swap_b32 v251, v253
    v_fma_f32 v253, -v251, v251, v253
    v_max_f32 v253, 0, v253
    v_add_f32 v253, 0x3727c5ac, v253
    v_rsq_f32 v253, v253
    v_and_b32 v95, 0xffff0000, v179
    v_mul_f32 v250, 0x3eeff558, v253
    v_mul_f32 v252, -v251, v250
    ds_read_b32 v249, v243 offset:0
    v_pk_fma_f32 v[72:73], v[72:73], v[250:251], v[252:253] op_sel_hi:[1,0,0]
    v_pk_fma_f32 v[74:75], v[74:75], v[250:251], v[252:253] op_sel_hi:[1,0,0]
    v_pk_fma_f32 v[76:77], v[76:77], v[250:251], v[252:253] op_sel_hi:[1,0,0]
    v_pk_fma_f32 v[78:79], v[78:79], v[250:251], v[252:253] op_sel_hi:[1,0,0]
    v_pk_fma_f32 v[80:81], v[80:81], v[250:251], v[252:253] op_sel_hi:[1,0,0]
    v_pk_fma_f32 v[82:83], v[82:83], v[250:251], v[252:253] op_sel_hi:[1,0,0]
    v_pk_fma_f32 v[84:85], v[84:85], v[250:251], v[252:253] op_sel_hi:[1,0,0]
    v_pk_fma_f32 v[86:87], v[86:87], v[250:251], v[252:253] op_sel_hi:[1,0,0]
    v_pk_fma_f32 v[88:89], v[88:89], v[250:251], v[252:253] op_sel_hi:[1,0,0]
    v_pk_fma_f32 v[90:91], v[90:91], v[250:251], v[252:253] op_sel_hi:[1,0,0]
    v_pk_fma_f32 v[92:93], v[92:93], v[250:251], v[252:253] op_sel_hi:[1,0,0]
    v_pk_fma_f32 v[94:95], v[94:95], v[250:251], v[252:253] op_sel_hi:[1,0,0]
    s_waitcnt lgkmcnt(0)
    v_cmp_gt_u32 vcc, 2, v249
    s_cbranch_vccnz L_slow18
L_back18:
    ds_read_b64_tr_b16 v[144:145], v204 offset:0
    ds_read_b64_tr_b16 v[146:147], v204 offset:512
    ds_read_b64_tr_b16 v[148:149], v204 offset:4096
    ds_read_b64_tr_b16 v[150:151], v204 offset:4608
    ds_read_b64_tr_b16 v[152:153], v204 offset:8192
    ds_read_b64_tr_b16 v[154:155], v204 offset:8704
    ds_read_b64_tr_b16 v[156:157], v205 offset:0
    ds_read_b64_tr_b16 v[158:159], v205 offset:512
    ds_read_b64_tr_b16 v[160:161], v205 offset:4096
    ds_read_b64_tr_b16 v[162:163], v205 offset:4608
    ds_read_b64_tr_b16 v[164:165], v205 offset:8192
    ds_read_b64_tr_b16 v[166:167], v205 offset:8704
    v_cvt_pk_bf16_f32 v48, v72, v73
    v_cvt_pk_bf16_f32 v49, v74, v75
    v_cvt_pk_bf16_f32 v50, v76, v77
    v_cvt_pk_bf16_f32 v51, v78, v79
    v_cvt_pk_bf16_f32 v52, v80, v81
    v_cvt_pk_bf16_f32 v53, v82, v83
    v_cvt_pk_bf16_f32 v54, v84, v85
    v_cvt_pk_bf16_f32 v55, v86, v87
    v_cvt_pk_bf16_f32 v56, v88, v89
    v_cvt_pk_bf16_f32 v57, v90, v91
    v_cvt_pk_bf16_f32 v58, v92, v93
    v_cvt_pk_bf16_f32 v59, v94, v95
    s_waitcnt lgkmcnt(0)
    v_mfma_f32_16x16x32_bf16 v[72:75], v[144:147], v[48:51], 0
    v_mfma_f32_16x16x32_bf16 v[76:79], v[156:159], v[48:51], 0
    v_mfma_f32_16x16x32_bf16 v[72:75], v[148:151], v[52:55], v[72:75]
    v_mfma_f32_16x16x32_bf16 v[76:79], v[160:163], v[52:55], v[76:79]
    v_mfma_f32_16x16x32_bf16 v[72:75], v[152:155], v[56:59], v[72:75]
    v_mfma_f32_16x16x32_bf16 v[76:79], v[164:167], v[56:59], v[76:79]
    ds_read_b64_tr_b16 v[144:145], v206 offset:0
    ds_read_b64_tr_b16 v[146:147], v206 offset:512
    ds_read_b64_tr_b16 v[148:149], v206 offset:4096
    ds_read_b64_tr_b16 v[150:151], v206 offset:4608
    ds_read_b64_tr_b16 v[152:153], v206 offset:8192
    ds_read_b64_tr_b16 v[154:155], v206 offset:8704
    ds_read_b64_tr_b16 v[156:157], v207 offset:0
    ds_read_b64_tr_b16 v[158:159], v207 offset:512
    ds_read_b64_tr_b16 v[160:161], v207 offset:4096
    ds_read_b64_tr_b16 v[162:163], v207 offset:4608
    ds_read_b64_tr_b16 v[164:165], v207 offset:8192
    ds_read_b64_tr_b16 v[166:167], v207 offset:8704
    ds_read_b32 v249, v243 offset:16
    s_setprio 1
    v_pk_fma_f32 v[104:105], v[72:73], v[72:73], s[50:51] neg_lo:[1,0,0] neg_hi:[1,0,0]
    v_pk_fma_f32 v[106:107], v[74:75], v[74:75], s[50:51] neg_lo:[1,0,0] neg_hi:[1,0,0]
    v_pk_fma_f32 v[108:109], v[76:77], v[76:77], s[50:51] neg_lo:[1,0,0] neg_hi:[1,0,0]
    v_pk_fma_f32 v[110:111], v[78:79], v[78:79], s[50:51] neg_lo:[1,0,0] neg_hi:[1,0,0]
    v_pk_mul_f32 v[104:105], v[72:73], v[104:105]
    v_pk_mul_f32 v[106:107], v[74:75], v[106:107]
    v_pk_mul_f32 v[108:109], v[76:77], v[108:109]
    v_pk_mul_f32 v[110:111], v[78:79], v[110:111]
    s_waitcnt lgkmcnt(0)
    v_mfma_f32_16x16x32_bf16 v[88:91], v[144:147], v[48:51], 0
    v_exp_f32 v104, v104
    v_exp_f32 v105, v105
    v_mfma_f32_16x16x32_bf16 v[92:95], v[156:159], v[48:51], 0
    v_exp_f32 v106, v106
    v_exp_f32 v107, v107
    v_mfma_f32_16x16x32_bf16 v[88:91], v[148:151], v[52:55], v[88:91]
    v_exp_f32 v108, v108
    v_mfma_f32_16x16x32_bf16 v[92:95], v[160:163], v[52:55], v[92:95]
    v_exp_f32 v109, v109
    v_mfma_f32_16x16x32_bf16 v[88:91], v[152:155], v[56:59], v[88:91]
    v_exp_f32 v110, v110
    v_mfma_f32_16x16x32_bf16 v[92:95], v[164:167], v[56:59], v[92:95]
    s_waitcnt lgkmcnt(0)
    v_exp_f32 v111, v111
    v_cmp_gt_u32 vcc, 3, v249
    s_cbranch_vccnz L_slow19
L_back19:
    s_setprio 0
    ds_read_b64_tr_b16 v[144:145], v208 offset:0
    ds_read_b64_tr_b16 v[146:147], v208 offset:512
    ds_read_b64_tr_b16 v[148:149], v208 offset:4096
    ds_read_b64_tr_b16 v[150:151], v208 offset:4608
    ds_read_b64_tr_b16 v[152:153], v208 offset:8192
    ds_read_b64_tr_b16 v[154:155], v208 offset:8704
    ds_read_b64_tr_b16 v[156:157], v209 offset:0
    ds_read_b64_tr_b16 v[158:159], v209 offset:512
    ds_read_b64_tr_b16 v[160:161], v209 offset:4096
    ds_read_b64_tr_b16 v[162:163], v209 offset:4608
    ds_read_b64_tr_b16 v[164:165], v209 offset:8192
    ds_read_b64_tr_b16 v[166:167], v209 offset:8704
    s_add_u32 m0, s59, 49152
    s_add_u32 s43, s58, 256
    buffer_load_dwordx4 v220, s[28:31], s43 offen lds
    s_add_u32 m0, s59, 50176
    s_add_u32 s43, s58, 6400
    buffer_load_dwordx4 v224, s[28:31], s43 offen lds
    s_add_u32 m0, s59, 51200
    s_add_u32 s43, s58, 12544
    buffer_load_dwordx4 v220, s[28:31], s43 offen lds
    s_add_u32 m0, s59, 73728
    s_add_u32 s43, s58, 384
    buffer_load_dwordx4 v220, s[28:31], s43 offen lds
    s_add_u32 m0, s59, 74752
    s_add_u32 s43, s58, 6528
    buffer_load_dwordx4 v224, s[28:31], s43 offen lds
    s_add_u32 m0, s59, 75776
    s_add_u32 s43, s58, 12672
    buffer_load_dwordx4 v220, s[28:31], s43 offen lds
    ds_read_b32 v249, v243 offset:0
    s_setprio 1
    v_pk_fma_f32 v[104:105], v[104:105], s[48:49], s[48:49]
    v_pk_fma_f32 v[106:107], v[106:107], s[48:49], s[48:49]
    v_pk_fma_f32 v[108:109], v[108:109], s[48:49], s[48:49]
    v_pk_fma_f32 v[110:111], v[110:111], s[48:49], s[48:49]
    v_rcp_f32 v104, v104
    v_rcp_f32 v105, v105
    v_rcp_f32 v106, v106
    v_rcp_f32 v107, v107
    v_rcp_f32 v108, v108
    v_rcp_f32 v109, v109
    v_rcp_f32 v110, v110
    v_rcp_f32 v111, v111
    s_waitcnt lgkmcnt(0)
    v_cmp_gt_u32 vcc, 3, v249
    s_cbranch_vccnz L_slow20
L_back20:
    s_setprio 0
    ds_read_b64_tr_b16 v[168:169], v212 offset:0
    ds_read_b64_tr_b16 v[170:171], v212 offset:3072
    ds_read_b64_tr_b16 v[172:173], v213 offset:0
    ds_read_b64_tr_b16 v[174:175], v213 offset:3072
    ds_read_b64_tr_b16 v[176:177], v212 offset:64
    ds_read_b64_tr_b16 v[178:179], v212 offset:3136
    ds_read_b64_tr_b16 v[180:181], v213 offset:64
    ds_read_b64_tr_b16 v[182:183], v213 offset:3136
    ds_read_b64_tr_b16 v[184:185], v212 offset:128
    ds_read_b64_tr_b16 v[186:187], v212 offset:3200
    ds_read_b64_tr_b16 v[188:189], v213 offset:128
    ds_read_b64_tr_b16 v[190:191], v213 offset:3200
    s_add_u32 m0, s59, 61440
    s_add_u32 s43, s59, 24576
    buffer_load_dwordx4 v221, s[32:35], s43 offen offset:0 lds
    buffer_load_dwordx4 v222, s[32:35], s43 offen offset:1024 lds
    buffer_load_dwordx4 v223, s[32:35], s43 offen offset:2048 lds
    s_setprio 1
    v_pk_mul_f32 v[104:105], v[72:73], v[104:105]
    v_pk_mul_f32 v[106:107], v[74:75], v[106:107]
    v_pk_mul_f32 v[108:109], v[76:77], v[108:109]
    v_pk_mul_f32 v[110:111], v[78:79], v[110:111]
    v_pk_fma_f32 v[120:121], v[88:89], v[88:89], s[50:51] neg_lo:[1,0,0] neg_hi:[1,0,0]
    v_pk_fma_f32 v[122:123], v[90:91], v[90:91], s[50:51] neg_lo:[1,0,0] neg_hi:[1,0,0]
    v_pk_fma_f32 v[124:125], v[92:93], v[92:93], s[50:51] neg_lo:[1,0,0] neg_hi:[1,0,0]
    v_pk_fma_f32 v[126:127], v[94:95], v[94:95], s[50:51] neg_lo:[1,0,0] neg_hi:[1,0,0]
    v_pk_mul_f32 v[120:121], v[88:89], v[120:121]
    v_pk_mul_f32 v[122:123], v[90:91], v[122:123]
    v_pk_mul_f32 v[124:125], v[92:93], v[124:125]
    v_pk_mul_f32 v[126:127], v[94:95], v[126:127]
    v_mfma_f32_16x16x32_bf16 v[72:75], v[144:147], v[48:51], 0
    v_cvt_pk_bf16_f32 v136, v104, v105
    v_cvt_pk_bf16_f32 v137, v106, v107
    v_mfma_f32_16x16x32_bf16 v[76:79], v[156:159], v[48:51], 0
    v_cvt_pk_bf16_f32 v138, v108, v109
    v_cvt_pk_bf16_f32 v139, v110, v111
    v_mfma_f32_16x16x32_bf16 v[72:75], v[148:151], v[52:55], v[72:75]
    v_exp_f32 v120, v120
    v_exp_f32 v121, v121
    v_mfma_f32_16x16x32_bf16 v[76:79], v[160:163], v[52:55], v[76:79]
    v_exp_f32 v122, v122
    v_exp_f32 v123, v123
    v_mfma_f32_16x16x32_bf16 v[72:75], v[152:155], v[56:59], v[72:75]
    v_exp_f32 v124, v124
    v_exp_f32 v125, v125
    v_mfma_f32_16x16x32_bf16 v[76:79], v[164:167], v[56:59], v[76:79]
    s_waitcnt lgkmcnt(0)
    v_exp_f32 v126, v126
    v_exp_f32 v127, v127
    s_setprio 0
    ds_read_b64_tr_b16 v[144:145], v210 offset:0
    ds_read_b64_tr_b16 v[146:147], v210 offset:512
    ds_read_b64_tr_b16 v[148:149], v210 offset:4096
    ds_read_b64_tr_b16 v[150:151], v210 offset:4608
    ds_read_b64_tr_b16 v[152:153], v210 offset:8192
    ds_read_b64_tr_b16 v[154:155], v210 offset:8704
    ds_read_b64_tr_b16 v[156:157], v211 offset:0
    ds_read_b64_tr_b16 v[158:159], v211 offset:512
    ds_read_b64_tr_b16 v[160:161], v211 offset:4096
    ds_read_b64_tr_b16 v[162:163], v211 offset:4608
    ds_read_b64_tr_b16 v[164:165], v211 offset:8192
    ds_read_b64_tr_b16 v[166:167], v211 offset:8704
    s_add_u32 m0, s59, 86016
    s_add_u32 s43, s59, 36864
    buffer_load_dwordx4 v221, s[32:35], s43 offen offset:0 lds
    buffer_load_dwordx4 v222, s[32:35], s43 offen offset:1024 lds
    buffer_load_dwordx4 v223, s[32:35], s43 offen offset:2048 lds
    s_setprio 1
    v_pk_fma_f32 v[120:121], v[120:121], s[48:49], s[48:49]
    v_pk_fma_f32 v[122:123], v[122:123], s[48:49], s[48:49]
    v_pk_fma_f32 v[124:125], v[124:125], s[48:49], s[48:49]
    v_pk_fma_f32 v[126:127], v[126:127], s[48:49], s[48:49]
    v_mfma_f32_16x16x32_bf16 v[0:3], v[168:171], v[136:139], v[0:3]
    v_rcp_f32 v120, v120
    v_rcp_f32 v121, v121
    v_mfma_f32_16x16x32_bf16 v[4:7], v[172:175], v[136:139], v[4:7]
    v_rcp_f32 v122, v122
    v_rcp_f32 v123, v123
    v_mfma_f32_16x16x32_bf16 v[8:11], v[176:179], v[136:139], v[8:11]
    v_rcp_f32 v124, v124
    v_mfma_f32_16x16x32_bf16 v[12:15], v[180:183], v[136:139], v[12:15]
    v_rcp_f32 v125, v125
    v_mfma_f32_16x16x32_bf16 v[16:19], v[184:187], v[136:139], v[16:19]
    v_rcp_f32 v126, v126
    v_mfma_f32_16x16x32_bf16 v[20:23], v[188:191], v[136:139], v[20:23]
    s_waitcnt lgkmcnt(0)
    v_rcp_f32 v127, v127
    s_waitcnt vmcnt(6)
    v_mov_b32 v254, 6
    ds_write_b32 v248, v254
    s_setprio 0
    ds_read_b64_tr_b16 v[168:169], v214 offset:0
    ds_read_b64_tr_b16 v[170:171], v214 offset:3072
    ds_read_b64_tr_b16 v[172:173], v215 offset:0
    ds_read_b64_tr_b16 v[174:175], v215 offset:3072
    ds_read_b64_tr_b16 v[176:177], v214 offset:64
    ds_read_b64_tr_b16 v[178:179], v214 offset:3136
    ds_read_b64_tr_b16 v[180:181], v215 offset:64
    ds_read_b64_tr_b16 v[182:183], v215 offset:3136
    ds_read_b64_tr_b16 v[184:185], v214 offset:128
    ds_read_b64_tr_b16 v[186:187], v214 offset:3200
    ds_read_b64_tr_b16 v[188:189], v215 offset:128
    ds_read_b64_tr_b16 v[190:191], v215 offset:3200
    s_add_u32 m0, s59, 98304
    s_add_u32 s43, s58, 512
    buffer_load_dwordx4 v220, s[28:31], s43 offen lds
    s_add_u32 m0, s59, 99328
    s_add_u32 s43, s58, 6656
    buffer_load_dwordx4 v224, s[28:31], s43 offen lds
    s_add_u32 m0, s59, 100352
    s_add_u32 s43, s58, 12800
    buffer_load_dwordx4 v220, s[28:31], s43 offen lds
    ds_read_b32 v249, v243 offset:16
    s_setprio 1
    v_pk_mul_f32 v[120:121], v[88:89], v[120:121]
    v_pk_mul_f32 v[122:123], v[90:91], v[122:123]
    v_pk_mul_f32 v[124:125], v[92:93], v[124:125]
    v_pk_mul_f32 v[126:127], v[94:95], v[126:127]
    v_pk_fma_f32 v[104:105], v[72:73], v[72:73], s[50:51] neg_lo:[1,0,0] neg_hi:[1,0,0]
    v_pk_fma_f32 v[106:107], v[74:75], v[74:75], s[50:51] neg_lo:[1,0,0] neg_hi:[1,0,0]
    v_pk_fma_f32 v[108:109], v[76:77], v[76:77], s[50:51] neg_lo:[1,0,0] neg_hi:[1,0,0]
    v_pk_fma_f32 v[110:111], v[78:79], v[78:79], s[50:51] neg_lo:[1,0,0] neg_hi:[1,0,0]
    v_pk_mul_f32 v[104:105], v[72:73], v[104:105]
    v_pk_mul_f32 v[106:107], v[74:75], v[106:107]
    v_pk_mul_f32 v[108:109], v[76:77], v[108:109]
    v_pk_mul_f32 v[110:111], v[78:79], v[110:111]
    v_mfma_f32_16x16x32_bf16 v[88:91], v[144:147], v[48:51], 0
    v_cvt_pk_bf16_f32 v136, v120, v121
    v_cvt_pk_bf16_f32 v137, v122, v123
    v_mfma_f32_16x16x32_bf16 v[92:95], v[156:159], v[48:51], 0
    v_cvt_pk_bf16_f32 v138, v124, v125
    v_cvt_pk_bf16_f32 v139, v126, v127
    v_mfma_f32_16x16x32_bf16 v[88:91], v[148:151], v[52:55], v[88:91]
    v_exp_f32 v104, v104
    v_exp_f32 v105, v105
    v_mfma_f32_16x16x32_bf16 v[92:95], v[160:163], v[52:55], v[92:95]
    v_exp_f32 v106, v106
    v_exp_f32 v107, v107
    v_mfma_f32_16x16x32_bf16 v[88:91], v[152:155], v[56:59], v[88:91]
    v_exp_f32 v108, v108
    v_exp_f32 v109, v109
    v_mfma_f32_16x16x32_bf16 v[92:95], v[164:167], v[56:59], v[92:95]
    s_waitcnt lgkmcnt(0)
    v_exp_f32 v110, v110
    v_exp_f32 v111, v111
    v_cmp_gt_u32 vcc, 6, v249
    s_cbranch_vccnz L_slow21
L_back21:
    s_setprio 0
    ds_read_b64_tr_b16 v[144:145], v204 offset:49152
    ds_read_b64_tr_b16 v[146:147], v204 offset:49664
    ds_read_b64_tr_b16 v[148:149], v204 offset:53248
    ds_read_b64_tr_b16 v[150:151], v204 offset:53760
    ds_read_b64_tr_b16 v[152:153], v204 offset:57344
    ds_read_b64_tr_b16 v[154:155], v204 offset:57856
    ds_read_b64_tr_b16 v[156:157], v205 offset:49152
    ds_read_b64_tr_b16 v[158:159], v205 offset:49664
    ds_read_b64_tr_b16 v[160:161], v205 offset:53248
    ds_read_b64_tr_b16 v[162:163], v205 offset:53760
    ds_read_b64_tr_b16 v[164:165], v205 offset:57344
    ds_read_b64_tr_b16 v[166:167], v205 offset:57856
    s_add_u32 m0, s59, 110592
    s_add_u32 s43, s59, 49152
    buffer_load_dwordx4 v221, s[32:35], s43 offen offset:0 lds
    buffer_load_dwordx4 v222, s[32:35], s43 offen offset:1024 lds
    buffer_load_dwordx4 v223, s[32:35], s43 offen offset:2048 lds
    s_setprio 1
    v_pk_fma_f32 v[104:105], v[104:105], s[48:49], s[48:49]
    v_pk_fma_f32 v[106:107], v[106:107], s[48:49], s[48:49]
    v_pk_fma_f32 v[108:109], v[108:109], s[48:49], s[48:49]
    v_pk_fma_f32 v[110:111], v[110:111], s[48:49], s[48:49]
    v_mfma_f32_16x16x32_bf16 v[0:3], v[168:171], v[136:139], v[0:3]
    v_rcp_f32 v104, v104
    v_rcp_f32 v105, v105
    v_mfma_f32_16x16x32_bf16 v[4:7], v[172:175], v[136:139], v[4:7]
    v_rcp_f32 v106, v106
    v_rcp_f32 v107, v107
    v_mfma_f32_16x16x32_bf16 v[8:11], v[176:179], v[136:139], v[8:11]
    v_rcp_f32 v108, v108
    v_mfma_f32_16x16x32_bf16 v[12:15], v[180:183], v[136:139], v[12:15]
    v_rcp_f32 v109, v109
    v_mfma_f32_16x16x32_bf16 v[16:19], v[184:187], v[136:139], v[16:19]
    v_rcp_f32 v110, v110
    v_mfma_f32_16x16x32_bf16 v[20:23], v[188:191], v[136:139], v[20:23]
    s_waitcnt lgkmcnt(0)
    v_rcp_f32 v111, v111
    s_setprio 0
    ds_read_b64_tr_b16 v[168:169], v216 offset:0
    ds_read_b64_tr_b16 v[170:171], v216 offset:3072
    ds_read_b64_tr_b16 v[172:173], v217 offset:0
    ds_read_b64_tr_b16 v[174:175], v217 offset:3072
    ds_read_b64_tr_b16 v[176:177], v216 offset:64
    ds_read_b64_tr_b16 v[178:179], v216 offset:3136
    ds_read_b64_tr_b16 v[180:181], v217 offset:64
    ds_read_b64_tr_b16 v[182:183], v217 offset:3136
    ds_read_b64_tr_b16 v[184:185], v216 offset:128
    ds_read_b64_tr_b16 v[186:187], v216 offset:3200
    ds_read_b64_tr_b16 v[188:189], v217 offset:128
    ds_read_b64_tr_b16 v[190:191], v217 offset:3200
    s_add_u32 m0, s59, 122880
    s_add_u32 s43, s58, 640
    buffer_load_dwordx4 v220, s[28:31], s43 offen lds
    s_add_u32 m0, s59, 123904
    s_add_u32 s43, s58, 6784
    buffer_load_dwordx4 v224, s[28:31], s43 offen lds
    s_add_u32 m0, s59, 124928
    s_add_u32 s43, s58, 12928
    buffer_load_dwordx4 v220, s[28:31], s43 offen lds
    s_setprio 0
    v_pk_mul_f32 v[104:105], v[72:73], v[104:105]
    v_pk_mul_f32 v[106:107], v[74:75], v[106:107]
    v_pk_mul_f32 v[108:109], v[76:77], v[108:109]
    v_pk_mul_f32 v[110:111], v[78:79], v[110:111]
    v_pk_fma_f32 v[120:121], v[88:89], v[88:89], s[50:51] neg_lo:[1,0,0] neg_hi:[1,0,0]
    v_pk_fma_f32 v[122:123], v[90:91], v[90:91], s[50:51] neg_lo:[1,0,0] neg_hi:[1,0,0]
    v_pk_fma_f32 v[124:125], v[92:93], v[92:93], s[50:51] neg_lo:[1,0,0] neg_hi:[1,0,0]
    v_pk_fma_f32 v[126:127], v[94:95], v[94:95], s[50:51] neg_lo:[1,0,0] neg_hi:[1,0,0]
    v_pk_mul_f32 v[120:121], v[88:89], v[120:121]
    v_pk_mul_f32 v[122:123], v[90:91], v[122:123]
    v_pk_mul_f32 v[124:125], v[92:93], v[124:125]
    v_pk_mul_f32 v[126:127], v[94:95], v[126:127]
    v_mfma_f32_16x16x32_bf16 v[72:75], v[144:147], v[48:51], 0
    v_cvt_pk_bf16_f32 v136, v104, v105
    v_cvt_pk_bf16_f32 v137, v106, v107
    v_mfma_f32_16x16x32_bf16 v[76:79], v[156:159], v[48:51], 0
    v_cvt_pk_bf16_f32 v138, v108, v109
    v_cvt_pk_bf16_f32 v139, v110, v111
    v_mfma_f32_16x16x32_bf16 v[72:75], v[148:151], v[52:55], v[72:75]
    v_exp_f32 v120, v120
    v_exp_f32 v121, v121
    v_mfma_f32_16x16x32_bf16 v[76:79], v[160:163], v[52:55], v[76:79]
    v_exp_f32 v122, v122
    v_exp_f32 v123, v123
    v_mfma_f32_16x16x32_bf16 v[72:75], v[152:155], v[56:59], v[72:75]
    v_exp_f32 v124, v124
    v_exp_f32 v125, v125
    v_mfma_f32_16x16x32_bf16 v[76:79], v[164:167], v[56:59], v[76:79]
    s_waitcnt lgkmcnt(0)
    v_exp_f32 v126, v126
    v_exp_f32 v127, v127
    s_waitcnt vmcnt(9)
    v_mov_b32 v254, 7
    ds_write_b32 v248, v254
    s_setprio 0
    ds_read_b64_tr_b16 v[144:145], v206 offset:49152
    ds_read_b64_tr_b16 v[146:147], v206 offset:49664
    ds_read_b64_tr_b16 v[148:149], v206 offset:53248
    ds_read_b64_tr_b16 v[150:151], v206 offset:53760
    ds_read_b64_tr_b16 v[152:153], v206 offset:57344
    ds_read_b64_tr_b16 v[154:155], v206 offset:57856
    ds_read_b64_tr_b16 v[156:157], v207 offset:49152
    ds_read_b64_tr_b16 v[158:159], v207 offset:49664
    ds_read_b64_tr_b16 v[160:161], v207 offset:53248
    ds_read_b64_tr_b16 v[162:163], v207 offset:53760
    ds_read_b64_tr_b16 v[164:165], v207 offset:57344
    ds_read_b64_tr_b16 v[166:167], v207 offset:57856
    s_add_u32 m0, s59, 135168
    s_add_u32 s43, s59, 61440
    buffer_load_dwordx4 v221, s[32:35], s43 offen offset:0 lds
    buffer_load_dwordx4 v222, s[32:35], s43 offen offset:1024 lds
    buffer_load_dwordx4 v223, s[32:35], s43 offen offset:2048 lds
    s_setprio 0
    v_pk_fma_f32 v[120:121], v[120:121], s[48:49], s[48:49]
    v_pk_fma_f32 v[122:123], v[122:123], s[48:49], s[48:49]
    v_pk_fma_f32 v[124:125], v[124:125], s[48:49], s[48:49]
    v_pk_fma_f32 v[126:127], v[126:127], s[48:49], s[48:49]
    v_mfma_f32_16x16x32_bf16 v[0:3], v[168:171], v[136:139], v[0:3]
    v_rcp_f32 v120, v120
    v_rcp_f32 v121, v121
    v_mfma_f32_16x16x32_bf16 v[4:7], v[172:175], v[136:139], v[4:7]
    v_rcp_f32 v122, v122
    v_rcp_f32 v123, v123
    v_mfma_f32_16x16x32_bf16 v[8:11], v[176:179], v[136:139], v[8:11]
    v_rcp_f32 v124, v124
    v_mfma_f32_16x16x32_bf16 v[12:15], v[180:183], v[136:139], v[12:15]
    v_rcp_f32 v125, v125
    v_mfma_f32_16x16x32_bf16 v[16:19], v[184:187], v[136:139], v[16:19]
    v_rcp_f32 v126, v126
    v_mfma_f32_16x16x32_bf16 v[20:23], v[188:191], v[136:139], v[20:23]
    s_waitcnt lgkmcnt(0)
    v_rcp_f32 v127, v127
    s_setprio 0
    ds_read_b64_tr_b16 v[168:169], v218 offset:0
    ds_read_b64_tr_b16 v[170:171], v218 offset:3072
    ds_read_b64_tr_b16 v[172:173], v219 offset:0
    ds_read_b64_tr_b16 v[174:175], v219 offset:3072
    ds_read_b64_tr_b16 v[176:177], v218 offset:64
    ds_read_b64_tr_b16 v[178:179], v218 offset:3136
    ds_read_b64_tr_b16 v[180:181], v219 offset:64
    ds_read_b64_tr_b16 v[182:183], v219 offset:3136
    ds_read_b64_tr_b16 v[184:185], v218 offset:128
    ds_read_b64_tr_b16 v[186:187], v218 offset:3200
    ds_read_b64_tr_b16 v[188:189], v219 offset:128
    ds_read_b64_tr_b16 v[190:191], v219 offset:3200
    v_pk_mul_f32 v[120:121], v[88:89], v[120:121]
    v_pk_mul_f32 v[122:123], v[90:91], v[122:123]
    v_pk_mul_f32 v[124:125], v[92:93], v[124:125]
    v_pk_mul_f32 v[126:127], v[94:95], v[126:127]
    v_pk_fma_f32 v[104:105], v[72:73], v[72:73], s[50:51] neg_lo:[1,0,0] neg_hi:[1,0,0]
    v_pk_fma_f32 v[106:107], v[74:75], v[74:75], s[50:51] neg_lo:[1,0,0] neg_hi:[1,0,0]
    v_pk_fma_f32 v[108:109], v[76:77], v[76:77], s[50:51] neg_lo:[1,0,0] neg_hi:[1,0,0]
    v_pk_fma_f32 v[110:111], v[78:79], v[78:79], s[50:51] neg_lo:[1,0,0] neg_hi:[1,0,0]
    v_pk_mul_f32 v[104:105], v[72:73], v[104:105]
    v_pk_mul_f32 v[106:107], v[74:75], v[106:107]
    v_pk_mul_f32 v[108:109], v[76:77], v[108:109]
    v_pk_mul_f32 v[110:111], v[78:79], v[110:111]
    v_mfma_f32_16x16x32_bf16 v[88:91], v[144:147], v[48:51], 0
    v_cvt_pk_bf16_f32 v136, v120, v121
    v_cvt_pk_bf16_f32 v137, v122, v123
    v_mfma_f32_16x16x32_bf16 v[92:95], v[156:159], v[48:51], 0
    v_cvt_pk_bf16_f32 v138, v124, v125
    v_cvt_pk_bf16_f32 v139, v126, v127
    v_mfma_f32_16x16x32_bf16 v[88:91], v[148:151], v[52:55], v[88:91]
    v_exp_f32 v104, v104
    v_exp_f32 v105, v105
    v_mfma_f32_16x16x32_bf16 v[92:95], v[160:163], v[52:55], v[92:95]
    v_exp_f32 v106, v106
    v_exp_f32 v107, v107
    v_mfma_f32_16x16x32_bf16 v[88:91], v[152:155], v[56:59], v[88:91]
    v_exp_f32 v108, v108
    v_exp_f32 v109, v109
    v_mfma_f32_16x16x32_bf16 v[92:95], v[164:167], v[56:59], v[92:95]
    s_waitcnt lgkmcnt(0)
    v_exp_f32 v110, v110
    v_exp_f32 v111, v111
    ds_read_b64_tr_b16 v[144:145], v208 offset:49152
    ds_read_b64_tr_b16 v[146:147], v208 offset:49664
    ds_read_b64_tr_b16 v[148:149], v208 offset:53248
    ds_read_b64_tr_b16 v[150:151], v208 offset:53760
    ds_read_b64_tr_b16 v[152:153], v208 offset:57344
    ds_read_b64_tr_b16 v[154:155], v208 offset:57856
    ds_read_b64_tr_b16 v[156:157], v209 offset:49152
    ds_read_b64_tr_b16 v[158:159], v209 offset:49664
    ds_read_b64_tr_b16 v[160:161], v209 offset:53248
    ds_read_b64_tr_b16 v[162:163], v209 offset:53760
    ds_read_b64_tr_b16 v[164:165], v209 offset:57344
    ds_read_b64_tr_b16 v[166:167], v209 offset:57856
    ds_read_b32 v249, v243 offset:16
    v_pk_fma_f32 v[104:105], v[104:105], s[48:49], s[48:49]
    v_pk_fma_f32 v[106:107], v[106:107], s[48:49], s[48:49]
    v_pk_fma_f32 v[108:109], v[108:109], s[48:49], s[48:49]
    v_pk_fma_f32 v[110:111], v[110:111], s[48:49], s[48:49]
    v_mfma_f32_16x16x32_bf16 v[0:3], v[168:171], v[136:139], v[0:3]
    v_rcp_f32 v104, v104
    v_rcp_f32 v105, v105
    v_mfma_f32_16x16x32_bf16 v[4:7], v[172:175], v[136:139], v[4:7]
    v_rcp_f32 v106, v106
    v_rcp_f32 v107, v107
    v_mfma_f32_16x16x32_bf16 v[8:11], v[176:179], v[136:139], v[8:11]
    v_rcp_f32 v108, v108
    v_mfma_f32_16x16x32_bf16 v[12:15], v[180:183], v[136:139], v[12:15]
    v_rcp_f32 v109, v109
    v_mfma_f32_16x16x32_bf16 v[16:19], v[184:187], v[136:139], v[16:19]
    v_rcp_f32 v110, v110
    v_mfma_f32_16x16x32_bf16 v[20:23], v[188:191], v[136:139], v[20:23]
    s_waitcnt lgkmcnt(0)
    v_rcp_f32 v111, v111
    v_cmp_gt_u32 vcc, 7, v249
    s_cbranch_vccnz L_slow22
L_back22:
    s_waitcnt vmcnt(0)
    v_mov_b32 v254, 8
    ds_write_b32 v248, v254
    ds_read_b64_tr_b16 v[168:169], v212 offset:49152
    ds_read_b64_tr_b16 v[170:171], v212 offset:52224
    ds_read_b64_tr_b16 v[172:173], v213 offset:49152
    ds_read_b64_tr_b16 v[174:175], v213 offset:52224
    ds_read_b64_tr_b16 v[176:177], v212 offset:49216
    ds_read_b64_tr_b16 v[178:179], v212 offset:52288
    ds_read_b64_tr_b16 v[180:181], v213 offset:49216
    ds_read_b64_tr_b16 v[182:183], v213 offset:52288
    ds_read_b64_tr_b16 v[184:185], v212 offset:49280
    ds_read_b64_tr_b16 v[186:187], v212 offset:52352
    ds_read_b64_tr_b16 v[188:189], v213 offset:49280
    ds_read_b64_tr_b16 v[190:191], v213 offset:52352
    v_pk_mul_f32 v[104:105], v[72:73], v[104:105]
    v_pk_mul_f32 v[106:107], v[74:75], v[106:107]
    v_pk_mul_f32 v[108:109], v[76:77], v[108:109]
    v_pk_mul_f32 v[110:111], v[78:79], v[110:111]
    v_pk_fma_f32 v[120:121], v[88:89], v[88:89], s[50:51] neg_lo:[1,0,0] neg_hi:[1,0,0]
    v_pk_fma_f32 v[122:123], v[90:91], v[90:91], s[50:51] neg_lo:[1,0,0] neg_hi:[1,0,0]
    v_pk_fma_f32 v[124:125], v[92:93], v[92:93], s[50:51] neg_lo:[1,0,0] neg_hi:[1,0,0]
    v_pk_fma_f32 v[126:127], v[94:95], v[94:95], s[50:51] neg_lo:[1,0,0] neg_hi:[1,0,0]
    v_pk_mul_f32 v[120:121], v[88:89], v[120:121]
    v_pk_mul_f32 v[122:123], v[90:91], v[122:123]
    v_pk_mul_f32 v[124:125], v[92:93], v[124:125]
    v_pk_mul_f32 v[126:127], v[94:95], v[126:127]
    v_mfma_f32_16x16x32_bf16 v[72:75], v[144:147], v[48:51], 0
    v_cvt_pk_bf16_f32 v136, v104, v105
    v_cvt_pk_bf16_f32 v137, v106, v107
    v_mfma_f32_16x16x32_bf16 v[76:79], v[156:159], v[48:51], 0
    v_cvt_pk_bf16_f32 v138, v108, v109
    v_cvt_pk_bf16_f32 v139, v110, v111
    v_mfma_f32_16x16x32_bf16 v[72:75], v[148:151], v[52:55], v[72:75]
    v_exp_f32 v120, v120
    v_exp_f32 v121, v121
    v_mfma_f32_16x16x32_bf16 v[76:79], v[160:163], v[52:55], v[76:79]
    v_exp_f32 v122, v122
    v_exp_f32 v123, v123
    v_mfma_f32_16x16x32_bf16 v[72:75], v[152:155], v[56:59], v[72:75]
    v_exp_f32 v124, v124
    v_exp_f32 v125, v125
    v_mfma_f32_16x16x32_bf16 v[76:79], v[164:167], v[56:59], v[76:79]
    s_waitcnt lgkmcnt(0)
    v_exp_f32 v126, v126
    v_exp_f32 v127, v127
    ds_read_b64_tr_b16 v[144:145], v210 offset:49152
    ds_read_b64_tr_b16 v[146:147], v210 offset:49664
    ds_read_b64_tr_b16 v[148:149], v210 offset:53248
    ds_read_b64_tr_b16 v[150:151], v210 offset:53760
    ds_read_b64_tr_b16 v[152:153], v210 offset:57344
    ds_read_b64_tr_b16 v[154:155], v210 offset:57856
    ds_read_b64_tr_b16 v[156:157], v211 offset:49152
    ds_read_b64_tr_b16 v[158:159], v211 offset:49664
    ds_read_b64_tr_b16 v[160:161], v211 offset:53248
    ds_read_b64_tr_b16 v[162:163], v211 offset:53760
    ds_read_b64_tr_b16 v[164:165], v211 offset:57344
    ds_read_b64_tr_b16 v[166:167], v211 offset:57856
    v_pk_fma_f32 v[120:121], v[120:121], s[48:49], s[48:49]
    v_pk_fma_f32 v[122:123], v[122:123], s[48:49], s[48:49]
    v_pk_fma_f32 v[124:125], v[124:125], s[48:49], s[48:49]
    v_pk_fma_f32 v[126:127], v[126:127], s[48:49], s[48:49]
    v_mfma_f32_16x16x32_bf16 v[0:3], v[168:171], v[136:139], v[0:3]
    v_rcp_f32 v120, v120
    v_rcp_f32 v121, v121
    v_mfma_f32_16x16x32_bf16 v[4:7], v[172:175], v[136:139], v[4:7]
    v_rcp_f32 v122, v122
    v_rcp_f32 v123, v123
    v_mfma_f32_16x16x32_bf16 v[8:11], v[176:179], v[136:139], v[8:11]
    v_rcp_f32 v124, v124
    v_mfma_f32_16x16x32_bf16 v[12:15], v[180:183], v[136:139], v[12:15]
    v_rcp_f32 v125, v125
    v_mfma_f32_16x16x32_bf16 v[16:19], v[184:187], v[136:139], v[16:19]
    v_rcp_f32 v126, v126
    v_mfma_f32_16x16x32_bf16 v[20:23], v[188:191], v[136:139], v[20:23]
    s_waitcnt lgkmcnt(0)
    v_rcp_f32 v127, v127
    ds_read_b64_tr_b16 v[168:169], v214 offset:49152
    ds_read_b64_tr_b16 v[170:171], v214 offset:52224
    ds_read_b64_tr_b16 v[172:173], v215 offset:49152
    ds_read_b64_tr_b16 v[174:175], v215 offset:52224
    ds_read_b64_tr_b16 v[176:177], v214 offset:49216
    ds_read_b64_tr_b16 v[178:179], v214 offset:52288
    ds_read_b64_tr_b16 v[180:181], v215 offset:49216
    ds_read_b64_tr_b16 v[182:183], v215 offset:52288
    ds_read_b64_tr_b16 v[184:185], v214 offset:49280
    ds_read_b64_tr_b16 v[186:187], v214 offset:52352
    ds_read_b64_tr_b16 v[188:189], v215 offset:49280
    ds_read_b64_tr_b16 v[190:191], v215 offset:52352
    ds_read_b32 v249, v243 offset:16
    v_pk_mul_f32 v[120:121], v[88:89], v[120:121]
    v_pk_mul_f32 v[122:123], v[90:91], v[122:123]
    v_pk_mul_f32 v[124:125], v[92:93], v[124:125]
    v_pk_mul_f32 v[126:127], v[94:95], v[126:127]
    v_pk_fma_f32 v[104:105], v[72:73], v[72:73], s[50:51] neg_lo:[1,0,0] neg_hi:[1,0,0]
    v_pk_fma_f32 v[106:107], v[74:75], v[74:75], s[50:51] neg_lo:[1,0,0] neg_hi:[1,0,0]
    v_pk_fma_f32 v[108:109], v[76:77], v[76:77], s[50:51] neg_lo:[1,0,0] neg_hi:[1,0,0]
    v_pk_fma_f32 v[110:111], v[78:79], v[78:79], s[50:51] neg_lo:[1,0,0] neg_hi:[1,0,0]
    v_pk_mul_f32 v[104:105], v[72:73], v[104:105]
    v_pk_mul_f32 v[106:107], v[74:75], v[106:107]
    v_pk_mul_f32 v[108:109], v[76:77], v[108:109]
    v_pk_mul_f32 v[110:111], v[78:79], v[110:111]
    v_add_u32 v204, 98304, v204
    v_add_u32 v205, 98304, v205
    v_add_u32 v206, 98304, v206
    v_add_u32 v207, 98304, v207
    v_add_u32 v208, 98304, v208
    v_add_u32 v209, 98304, v209
    v_add_u32 v210, 98304, v210
    v_add_u32 v211, 98304, v211
    v_mfma_f32_16x16x32_bf16 v[88:91], v[144:147], v[48:51], 0
    v_cvt_pk_bf16_f32 v136, v120, v121
    v_cvt_pk_bf16_f32 v137, v122, v123
    v_mfma_f32_16x16x32_bf16 v[92:95], v[156:159], v[48:51], 0
    v_cvt_pk_bf16_f32 v138, v124, v125
    v_cvt_pk_bf16_f32 v139, v126, v127
    v_mfma_f32_16x16x32_bf16 v[88:91], v[148:151], v[52:55], v[88:91]
    v_exp_f32 v104, v104
    v_exp_f32 v105, v105
    v_mfma_f32_16x16x32_bf16 v[92:95], v[160:163], v[52:55], v[92:95]
    v_exp_f32 v106, v106
    v_exp_f32 v107, v107
    v_mfma_f32_16x16x32_bf16 v[88:91], v[152:155], v[56:59], v[88:91]
    v_exp_f32 v108, v108
    v_exp_f32 v109, v109
    v_mfma_f32_16x16x32_bf16 v[92:95], v[164:167], v[56:59], v[92:95]
    s_waitcnt lgkmcnt(0)
    v_exp_f32 v110, v110
    v_exp_f32 v111, v111
    v_cmp_gt_u32 vcc, 8, v249
    s_cbranch_vccnz L_slow23
L_back23:
    ds_read_b64_tr_b16 v[144:145], v204 offset:0
    ds_read_b64_tr_b16 v[146:147], v204 offset:512
    ds_read_b64_tr_b16 v[148:149], v204 offset:4096
    ds_read_b64_tr_b16 v[150:151], v204 offset:4608
    ds_read_b64_tr_b16 v[152:153], v204 offset:8192
    ds_read_b64_tr_b16 v[154:155], v204 offset:8704
    ds_read_b64_tr_b16 v[156:157], v205 offset:0
    ds_read_b64_tr_b16 v[158:159], v205 offset:512
    ds_read_b64_tr_b16 v[160:161], v205 offset:4096
    ds_read_b64_tr_b16 v[162:163], v205 offset:4608
    ds_read_b64_tr_b16 v[164:165], v205 offset:8192
    ds_read_b64_tr_b16 v[166:167], v205 offset:8704
    v_pk_fma_f32 v[104:105], v[104:105], s[48:49], s[48:49]
    v_pk_fma_f32 v[106:107], v[106:107], s[48:49], s[48:49]
    v_pk_fma_f32 v[108:109], v[108:109], s[48:49], s[48:49]
    v_pk_fma_f32 v[110:111], v[110:111], s[48:49], s[48:49]
    v_mfma_f32_16x16x32_bf16 v[0:3], v[168:171], v[136:139], v[0:3]
    v_rcp_f32 v104, v104
    v_rcp_f32 v105, v105
    v_mfma_f32_16x16x32_bf16 v[4:7], v[172:175], v[136:139], v[4:7]
    v_rcp_f32 v106, v106
    v_rcp_f32 v107, v107
    v_mfma_f32_16x16x32_bf16 v[8:11], v[176:179], v[136:139], v[8:11]
    v_rcp_f32 v108, v108
    v_mfma_f32_16x16x32_bf16 v[12:15], v[180:183], v[136:139], v[12:15]
    v_rcp_f32 v109, v109
    v_mfma_f32_16x16x32_bf16 v[16:19], v[184:187], v[136:139], v[16:19]
    v_rcp_f32 v110, v110
    v_mfma_f32_16x16x32_bf16 v[20:23], v[188:191], v[136:139], v[20:23]
    s_waitcnt lgkmcnt(0)
    v_rcp_f32 v111, v111
    ds_read_b64_tr_b16 v[168:169], v216 offset:49152
    ds_read_b64_tr_b16 v[170:171], v216 offset:52224
    ds_read_b64_tr_b16 v[172:173], v217 offset:49152
    ds_read_b64_tr_b16 v[174:175], v217 offset:52224
    ds_read_b64_tr_b16 v[176:177], v216 offset:49216
    ds_read_b64_tr_b16 v[178:179], v216 offset:52288
    ds_read_b64_tr_b16 v[180:181], v217 offset:49216
    ds_read_b64_tr_b16 v[182:183], v217 offset:52288
    ds_read_b64_tr_b16 v[184:185], v216 offset:49280
    ds_read_b64_tr_b16 v[186:187], v216 offset:52352
    ds_read_b64_tr_b16 v[188:189], v217 offset:49280
    ds_read_b64_tr_b16 v[190:191], v217 offset:52352
    v_pk_mul_f32 v[104:105], v[72:73], v[104:105]
    v_pk_mul_f32 v[106:107], v[74:75], v[106:107]
    v_pk_mul_f32 v[108:109], v[76:77], v[108:109]
    v_pk_mul_f32 v[110:111], v[78:79], v[110:111]
    v_pk_fma_f32 v[120:121], v[88:89], v[88:89], s[50:51] neg_lo:[1,0,0] neg_hi:[1,0,0]
    v_pk_fma_f32 v[122:123], v[90:91], v[90:91], s[50:51] neg_lo:[1,0,0] neg_hi:[1,0,0]
    v_pk_fma_f32 v[124:125], v[92:93], v[92:93], s[50:51] neg_lo:[1,0,0] neg_hi:[1,0,0]
    v_pk_fma_f32 v[126:127], v[94:95], v[94:95], s[50:51] neg_lo:[1,0,0] neg_hi:[1,0,0]
    v_pk_mul_f32 v[120:121], v[88:89], v[120:121]
    v_pk_mul_f32 v[122:123], v[90:91], v[122:123]
    v_pk_mul_f32 v[124:125], v[92:93], v[124:125]
    v_pk_mul_f32 v[126:127], v[94:95], v[126:127]
    v_mfma_f32_16x16x32_bf16 v[72:75], v[144:147], v[48:51], 0
    v_cvt_pk_bf16_f32 v136, v104, v105
    v_cvt_pk_bf16_f32 v137, v106, v107
    v_mfma_f32_16x16x32_bf16 v[76:79], v[156:159], v[48:51], 0
    v_cvt_pk_bf16_f32 v138, v108, v109
    v_cvt_pk_bf16_f32 v139, v110, v111
    v_mfma_f32_16x16x32_bf16 v[72:75], v[148:151], v[52:55], v[72:75]
    v_exp_f32 v120, v120
    v_exp_f32 v121, v121
    v_mfma_f32_16x16x32_bf16 v[76:79], v[160:163], v[52:55], v[76:79]
    v_exp_f32 v122, v122
    v_exp_f32 v123, v123
    v_mfma_f32_16x16x32_bf16 v[72:75], v[152:155], v[56:59], v[72:75]
    v_exp_f32 v124, v124
    v_exp_f32 v125, v125
    v_mfma_f32_16x16x32_bf16 v[76:79], v[164:167], v[56:59], v[76:79]
    s_waitcnt lgkmcnt(0)
    v_exp_f32 v126, v126
    v_exp_f32 v127, v127
    ds_read_b64_tr_b16 v[144:145], v206 offset:0
    ds_read_b64_tr_b16 v[146:147], v206 offset:512
    ds_read_b64_tr_b16 v[148:149], v206 offset:4096
    ds_read_b64_tr_b16 v[150:151], v206 offset:4608
    ds_read_b64_tr_b16 v[152:153], v206 offset:8192
    ds_read_b64_tr_b16 v[154:155], v206 offset:8704
    ds_read_b64_tr_b16 v[156:157], v207 offset:0
    ds_read_b64_tr_b16 v[158:159], v207 offset:512
    ds_read_b64_tr_b16 v[160:161], v207 offset:4096
    ds_read_b64_tr_b16 v[162:163], v207 offset:4608
    ds_read_b64_tr_b16 v[164:165], v207 offset:8192
    ds_read_b64_tr_b16 v[166:167], v207 offset:8704
    v_pk_fma_f32 v[120:121], v[120:121], s[48:49], s[48:49]
    v_pk_fma_f32 v[122:123], v[122:123], s[48:49], s[48:49]
    v_pk_fma_f32 v[124:125], v[124:125], s[48:49], s[48:49]
    v_pk_fma_f32 v[126:127], v[126:127], s[48:49], s[48:49]
    v_mfma_f32_16x16x32_bf16 v[0:3], v[168:171], v[136:139], v[0:3]
    v_rcp_f32 v120, v120
    v_rcp_f32 v121, v121
    v_mfma_f32_16x16x32_bf16 v[4:7], v[172:175], v[136:139], v[4:7]
    v_rcp_f32 v122, v122
    v_rcp_f32 v123, v123
    v_mfma_f32_16x16x32_bf16 v[8:11], v[176:179], v[136:139], v[8:11]
    v_rcp_f32 v124, v124
    v_mfma_f32_16x16x32_bf16 v[12:15], v[180:183], v[136:139], v[12:15]
    v_rcp_f32 v125, v125
    v_mfma_f32_16x16x32_bf16 v[16:19], v[184:187], v[136:139], v[16:19]
    v_rcp_f32 v126, v126
    v_mfma_f32_16x16x32_bf16 v[20:23], v[188:191], v[136:139], v[20:23]
    s_waitcnt lgkmcnt(0)
    v_rcp_f32 v127, v127
    ds_read_b64_tr_b16 v[168:169], v218 offset:49152
    ds_read_b64_tr_b16 v[170:171], v218 offset:52224
    ds_read_b64_tr_b16 v[172:173], v219 offset:49152
    ds_read_b64_tr_b16 v[174:175], v219 offset:52224
    ds_read_b64_tr_b16 v[176:177], v218 offset:49216
    ds_read_b64_tr_b16 v[178:179], v218 offset:52288
    ds_read_b64_tr_b16 v[180:181], v219 offset:49216
    ds_read_b64_tr_b16 v[182:183], v219 offset:52288
    ds_read_b64_tr_b16 v[184:185], v218 offset:49280
    ds_read_b64_tr_b16 v[186:187], v218 offset:52352
    ds_read_b64_tr_b16 v[188:189], v219 offset:49280
    ds_read_b64_tr_b16 v[190:191], v219 offset:52352
    v_pk_mul_f32 v[120:121], v[88:89], v[120:121]
    v_pk_mul_f32 v[122:123], v[90:91], v[122:123]
    v_pk_mul_f32 v[124:125], v[92:93], v[124:125]
    v_pk_mul_f32 v[126:127], v[94:95], v[126:127]
    v_pk_fma_f32 v[104:105], v[72:73], v[72:73], s[50:51] neg_lo:[1,0,0] neg_hi:[1,0,0]
    v_pk_fma_f32 v[106:107], v[74:75], v[74:75], s[50:51] neg_lo:[1,0,0] neg_hi:[1,0,0]
    v_pk_fma_f32 v[108:109], v[76:77], v[76:77], s[50:51] neg_lo:[1,0,0] neg_hi:[1,0,0]
    v_pk_fma_f32 v[110:111], v[78:79], v[78:79], s[50:51] neg_lo:[1,0,0] neg_hi:[1,0,0]
    v_pk_mul_f32 v[104:105], v[72:73], v[104:105]
    v_pk_mul_f32 v[106:107], v[74:75], v[106:107]
    v_pk_mul_f32 v[108:109], v[76:77], v[108:109]
    v_pk_mul_f32 v[110:111], v[78:79], v[110:111]
    v_add_u32 v212, 98304, v212
    v_add_u32 v213, 98304, v213
    v_add_u32 v214, 98304, v214
    v_add_u32 v215, 98304, v215
    v_add_u32 v216, 98304, v216
    v_add_u32 v217, 98304, v217
    v_add_u32 v218, 98304, v218
    v_add_u32 v219, 98304, v219
    v_mfma_f32_16x16x32_bf16 v[88:91], v[144:147], v[48:51], 0
    v_cvt_pk_bf16_f32 v136, v120, v121
    v_cvt_pk_bf16_f32 v137, v122, v123
    v_mfma_f32_16x16x32_bf16 v[92:95], v[156:159], v[48:51], 0
    v_cvt_pk_bf16_f32 v138, v124, v125
    v_cvt_pk_bf16_f32 v139, v126, v127
    v_mfma_f32_16x16x32_bf16 v[88:91], v[148:151], v[52:55], v[88:91]
    v_exp_f32 v104, v104
    v_exp_f32 v105, v105
    v_mfma_f32_16x16x32_bf16 v[92:95], v[160:163], v[52:55], v[92:95]
    v_exp_f32 v106, v106
    v_exp_f32 v107, v107
    v_mfma_f32_16x16x32_bf16 v[88:91], v[152:155], v[56:59], v[88:91]
    v_exp_f32 v108, v108
    v_exp_f32 v109, v109
    v_mfma_f32_16x16x32_bf16 v[92:95], v[164:167], v[56:59], v[92:95]
    s_waitcnt lgkmcnt(0)
    v_exp_f32 v110, v110
    v_exp_f32 v111, v111
    ds_read_b64_tr_b16 v[144:145], v208 offset:0
    ds_read_b64_tr_b16 v[146:147], v208 offset:512
    ds_read_b64_tr_b16 v[148:149], v208 offset:4096
    ds_read_b64_tr_b16 v[150:151], v208 offset:4608
    ds_read_b64_tr_b16 v[152:153], v208 offset:8192
    ds_read_b64_tr_b16 v[154:155], v208 offset:8704
    ds_read_b64_tr_b16 v[156:157], v209 offset:0
    ds_read_b64_tr_b16 v[158:159], v209 offset:512
    ds_read_b64_tr_b16 v[160:161], v209 offset:4096
    ds_read_b64_tr_b16 v[162:163], v209 offset:4608
    ds_read_b64_tr_b16 v[164:165], v209 offset:8192
    ds_read_b64_tr_b16 v[166:167], v209 offset:8704
    v_pk_fma_f32 v[104:105], v[104:105], s[48:49], s[48:49]
    v_pk_fma_f32 v[106:107], v[106:107], s[48:49], s[48:49]
    v_pk_fma_f32 v[108:109], v[108:109], s[48:49], s[48:49]
    v_pk_fma_f32 v[110:111], v[110:111], s[48:49], s[48:49]
    v_mfma_f32_16x16x32_bf16 v[0:3], v[168:171], v[136:139], v[0:3]
    v_rcp_f32 v104, v104
    v_rcp_f32 v105, v105
    v_mfma_f32_16x16x32_bf16 v[4:7], v[172:175], v[136:139], v[4:7]
    v_rcp_f32 v106, v106
    v_rcp_f32 v107, v107
    v_mfma_f32_16x16x32_bf16 v[8:11], v[176:179], v[136:139], v[8:11]
    v_rcp_f32 v108, v108
    v_mfma_f32_16x16x32_bf16 v[12:15], v[180:183], v[136:139], v[12:15]
    v_rcp_f32 v109, v109
    v_mfma_f32_16x16x32_bf16 v[16:19], v[184:187], v[136:139], v[16:19]
    v_rcp_f32 v110, v110
    v_mfma_f32_16x16x32_bf16 v[20:23], v[188:191], v[136:139], v[20:23]
    s_waitcnt lgkmcnt(0)
    v_rcp_f32 v111, v111
    ds_read_b64_tr_b16 v[168:169], v212 offset:0
    ds_read_b64_tr_b16 v[170:171], v212 offset:3072
    ds_read_b64_tr_b16 v[172:173], v213 offset:0
    ds_read_b64_tr_b16 v[174:175], v213 offset:3072
    ds_read_b64_tr_b16 v[176:177], v212 offset:64
    ds_read_b64_tr_b16 v[178:179], v212 offset:3136
    ds_read_b64_tr_b16 v[180:181], v213 offset:64
    ds_read_b64_tr_b16 v[182:183], v213 offset:3136
    ds_read_b64_tr_b16 v[184:185], v212 offset:128
    ds_read_b64_tr_b16 v[186:187], v212 offset:3200
    ds_read_b64_tr_b16 v[188:189], v213 offset:128
    ds_read_b64_tr_b16 v[190:191], v213 offset:3200
    v_pk_mul_f32 v[104:105], v[72:73], v[104:105]
    v_pk_mul_f32 v[106:107], v[74:75], v[106:107]
    v_pk_mul_f32 v[108:109], v[76:77], v[108:109]
    v_pk_mul_f32 v[110:111], v[78:79], v[110:111]
    v_pk_fma_f32 v[120:121], v[88:89], v[88:89], s[50:51] neg_lo:[1,0,0] neg_hi:[1,0,0]
    v_pk_fma_f32 v[122:123], v[90:91], v[90:91], s[50:51] neg_lo:[1,0,0] neg_hi:[1,0,0]
    v_pk_fma_f32 v[124:125], v[92:93], v[92:93], s[50:51] neg_lo:[1,0,0] neg_hi:[1,0,0]
    v_pk_fma_f32 v[126:127], v[94:95], v[94:95], s[50:51] neg_lo:[1,0,0] neg_hi:[1,0,0]
    v_pk_mul_f32 v[120:121], v[88:89], v[120:121]
    v_pk_mul_f32 v[122:123], v[90:91], v[122:123]
    v_pk_mul_f32 v[124:125], v[92:93], v[124:125]
    v_pk_mul_f32 v[126:127], v[94:95], v[126:127]
    v_mfma_f32_16x16x32_bf16 v[72:75], v[144:147], v[48:51], 0
    v_cvt_pk_bf16_f32 v136, v104, v105
    v_cvt_pk_bf16_f32 v137, v106, v107
    v_mfma_f32_16x16x32_bf16 v[76:79], v[156:159], v[48:51], 0
    v_cvt_pk_bf16_f32 v138, v108, v109
    v_cvt_pk_bf16_f32 v139, v110, v111
    v_mfma_f32_16x16x32_bf16 v[72:75], v[148:151], v[52:55], v[72:75]
    v_exp_f32 v120, v120
    v_exp_f32 v121, v121
    v_mfma_f32_16x16x32_bf16 v[76:79], v[160:163], v[52:55], v[76:79]
    v_exp_f32 v122, v122
    v_exp_f32 v123, v123
    v_mfma_f32_16x16x32_bf16 v[72:75], v[152:155], v[56:59], v[72:75]
    v_exp_f32 v124, v124
    v_exp_f32 v125, v125
    v_mfma_f32_16x16x32_bf16 v[76:79], v[164:167], v[56:59], v[76:79]
    s_waitcnt lgkmcnt(0)
    v_exp_f32 v126, v126
    v_exp_f32 v127, v127
    ds_read_b64_tr_b16 v[144:145], v210 offset:0
    ds_read_b64_tr_b16 v[146:147], v210 offset:512
    ds_read_b64_tr_b16 v[148:149], v210 offset:4096
    ds_read_b64_tr_b16 v[150:151], v210 offset:4608
    ds_read_b64_tr_b16 v[152:153], v210 offset:8192
    ds_read_b64_tr_b16 v[154:155], v210 offset:8704
    ds_read_b64_tr_b16 v[156:157], v211 offset:0
    ds_read_b64_tr_b16 v[158:159], v211 offset:512
    ds_read_b64_tr_b16 v[160:161], v211 offset:4096
    ds_read_b64_tr_b16 v[162:163], v211 offset:4608
    ds_read_b64_tr_b16 v[164:165], v211 offset:8192
    ds_read_b64_tr_b16 v[166:167], v211 offset:8704
    v_pk_fma_f32 v[120:121], v[120:121], s[48:49], s[48:49]
    v_pk_fma_f32 v[122:123], v[122:123], s[48:49], s[48:49]
    v_pk_fma_f32 v[124:125], v[124:125], s[48:49], s[48:49]
    v_pk_fma_f32 v[126:127], v[126:127], s[48:49], s[48:49]
    v_mfma_f32_16x16x32_bf16 v[0:3], v[168:171], v[136:139], v[0:3]
    v_rcp_f32 v120, v120
    v_rcp_f32 v121, v121
    v_mfma_f32_16x16x32_bf16 v[4:7], v[172:175], v[136:139], v[4:7]
    v_rcp_f32 v122, v122
    v_rcp_f32 v123, v123
    v_mfma_f32_16x16x32_bf16 v[8:11], v[176:179], v[136:139], v[8:11]
    v_rcp_f32 v124, v124
    v_mfma_f32_16x16x32_bf16 v[12:15], v[180:183], v[136:139], v[12:15]
    v_rcp_f32 v125, v125
    v_mfma_f32_16x16x32_bf16 v[16:19], v[184:187], v[136:139], v[16:19]
    v_rcp_f32 v126, v126
    v_mfma_f32_16x16x32_bf16 v[20:23], v[188:191], v[136:139], v[20:23]
    s_waitcnt lgkmcnt(0)
    v_rcp_f32 v127, v127
    ds_read_b64_tr_b16 v[168:169], v214 offset:0
    ds_read_b64_tr_b16 v[170:171], v214 offset:3072
    ds_read_b64_tr_b16 v[172:173], v215 offset:0
    ds_read_b64_tr_b16 v[174:175], v215 offset:3072
    ds_read_b64_tr_b16 v[176:177], v214 offset:64
    ds_read_b64_tr_b16 v[178:179], v214 offset:3136
    ds_read_b64_tr_b16 v[180:181], v215 offset:64
    ds_read_b64_tr_b16 v[182:183], v215 offset:3136
    ds_read_b64_tr_b16 v[184:185], v214 offset:128
    ds_read_b64_tr_b16 v[186:187], v214 offset:3200
    ds_read_b64_tr_b16 v[188:189], v215 offset:128
    ds_read_b64_tr_b16 v[190:191], v215 offset:3200
    v_pk_mul_f32 v[120:121], v[88:89], v[120:121]
    v_pk_mul_f32 v[122:123], v[90:91], v[122:123]
    v_pk_mul_f32 v[124:125], v[92:93], v[124:125]
    v_pk_mul_f32 v[126:127], v[94:95], v[126:127]
    v_pk_fma_f32 v[104:105], v[72:73], v[72:73], s[50:51] neg_lo:[1,0,0] neg_hi:[1,0,0]
    v_pk_fma_f32 v[106:107], v[74:75], v[74:75], s[50:51] neg_lo:[1,0,0] neg_hi:[1,0,0]
    v_pk_fma_f32 v[108:109], v[76:77], v[76:77], s[50:51] neg_lo:[1,0,0] neg_hi:[1,0,0]
    v_pk_fma_f32 v[110:111], v[78:79], v[78:79], s[50:51] neg_lo:[1,0,0] neg_hi:[1,0,0]
    v_pk_mul_f32 v[104:105], v[72:73], v[104:105]
    v_pk_mul_f32 v[106:107], v[74:75], v[106:107]
    v_pk_mul_f32 v[108:109], v[76:77], v[108:109]
    v_pk_mul_f32 v[110:111], v[78:79], v[110:111]
    v_mfma_f32_16x16x32_bf16 v[88:91], v[144:147], v[48:51], 0
    v_cvt_pk_bf16_f32 v136, v120, v121
    v_cvt_pk_bf16_f32 v137, v122, v123
    v_mfma_f32_16x16x32_bf16 v[92:95], v[156:159], v[48:51], 0
    v_cvt_pk_bf16_f32 v138, v124, v125
    v_cvt_pk_bf16_f32 v139, v126, v127
    v_mfma_f32_16x16x32_bf16 v[88:91], v[148:151], v[52:55], v[88:91]
    v_exp_f32 v104, v104
    v_exp_f32 v105, v105
    v_mfma_f32_16x16x32_bf16 v[92:95], v[160:163], v[52:55], v[92:95]
    v_exp_f32 v106, v106
    v_exp_f32 v107, v107
    v_mfma_f32_16x16x32_bf16 v[88:91], v[152:155], v[56:59], v[88:91]
    v_exp_f32 v108, v108
    v_exp_f32 v109, v109
    v_mfma_f32_16x16x32_bf16 v[92:95], v[164:167], v[56:59], v[92:95]
    s_waitcnt lgkmcnt(0)
    v_exp_f32 v110, v110
    v_exp_f32 v111, v111
    v_pk_fma_f32 v[104:105], v[104:105], s[48:49], s[48:49]
    v_pk_fma_f32 v[106:107], v[106:107], s[48:49], s[48:49]
    v_pk_fma_f32 v[108:109], v[108:109], s[48:49], s[48:49]
    v_pk_fma_f32 v[110:111], v[110:111], s[48:49], s[48:49]
    v_mfma_f32_16x16x32_bf16 v[0:3], v[168:171], v[136:139], v[0:3]
    v_rcp_f32 v104, v104
    v_rcp_f32 v105, v105
    v_mfma_f32_16x16x32_bf16 v[4:7], v[172:175], v[136:139], v[4:7]
    v_rcp_f32 v106, v106
    v_rcp_f32 v107, v107
    v_mfma_f32_16x16x32_bf16 v[8:11], v[176:179], v[136:139], v[8:11]
    v_rcp_f32 v108, v108
    v_mfma_f32_16x16x32_bf16 v[12:15], v[180:183], v[136:139], v[12:15]
    v_rcp_f32 v109, v109
    v_mfma_f32_16x16x32_bf16 v[16:19], v[184:187], v[136:139], v[16:19]
    v_rcp_f32 v110, v110
    v_mfma_f32_16x16x32_bf16 v[20:23], v[188:191], v[136:139], v[20:23]
    s_waitcnt lgkmcnt(0)
    v_rcp_f32 v111, v111
    ds_read_b64_tr_b16 v[168:169], v216 offset:0
    ds_read_b64_tr_b16 v[170:171], v216 offset:3072
    ds_read_b64_tr_b16 v[172:173], v217 offset:0
    ds_read_b64_tr_b16 v[174:175], v217 offset:3072
    ds_read_b64_tr_b16 v[176:177], v216 offset:64
    ds_read_b64_tr_b16 v[178:179], v216 offset:3136
    ds_read_b64_tr_b16 v[180:181], v217 offset:64
    ds_read_b64_tr_b16 v[182:183], v217 offset:3136
    ds_read_b64_tr_b16 v[184:185], v216 offset:128
    ds_read_b64_tr_b16 v[186:187], v216 offset:3200
    ds_read_b64_tr_b16 v[188:189], v217 offset:128
    ds_read_b64_tr_b16 v[190:191], v217 offset:3200
    v_pk_mul_f32 v[104:105], v[72:73], v[104:105]
    v_pk_mul_f32 v[106:107], v[74:75], v[106:107]
    v_pk_mul_f32 v[108:109], v[76:77], v[108:109]
    v_pk_mul_f32 v[110:111], v[78:79], v[110:111]
    v_pk_fma_f32 v[120:121], v[88:89], v[88:89], s[50:51] neg_lo:[1,0,0] neg_hi:[1,0,0]
    v_pk_fma_f32 v[122:123], v[90:91], v[90:91], s[50:51] neg_lo:[1,0,0] neg_hi:[1,0,0]
    v_pk_fma_f32 v[124:125], v[92:93], v[92:93], s[50:51] neg_lo:[1,0,0] neg_hi:[1,0,0]
    v_pk_fma_f32 v[126:127], v[94:95], v[94:95], s[50:51] neg_lo:[1,0,0] neg_hi:[1,0,0]
    v_pk_mul_f32 v[120:121], v[88:89], v[120:121]
    v_pk_mul_f32 v[122:123], v[90:91], v[122:123]
    v_pk_mul_f32 v[124:125], v[92:93], v[124:125]
    v_pk_mul_f32 v[126:127], v[94:95], v[126:127]
    v_cvt_pk_bf16_f32 v136, v104, v105
    v_cvt_pk_bf16_f32 v137, v106, v107
    v_cvt_pk_bf16_f32 v138, v108, v109
    v_cvt_pk_bf16_f32 v139, v110, v111
    v_exp_f32 v120, v120
    v_exp_f32 v121, v121
    v_exp_f32 v122, v122
    v_exp_f32 v123, v123
    v_exp_f32 v124, v124
    v_exp_f32 v125, v125
    v_exp_f32 v126, v126
    v_exp_f32 v127, v127
    s_waitcnt lgkmcnt(0)
    v_pk_fma_f32 v[120:121], v[120:121], s[48:49], s[48:49]
    v_pk_fma_f32 v[122:123], v[122:123], s[48:49], s[48:49]
    v_pk_fma_f32 v[124:125], v[124:125], s[48:49], s[48:49]
    v_pk_fma_f32 v[126:127], v[126:127], s[48:49], s[48:49]
    v_mfma_f32_16x16x32_bf16 v[0:3], v[168:171], v[136:139], v[0:3]
    v_rcp_f32 v120, v120
    v_rcp_f32 v121, v121
    v_mfma_f32_16x16x32_bf16 v[4:7], v[172:175], v[136:139], v[4:7]
    v_rcp_f32 v122, v122
    v_rcp_f32 v123, v123
    v_mfma_f32_16x16x32_bf16 v[8:11], v[176:179], v[136:139], v[8:11]
    v_rcp_f32 v124, v124
    v_mfma_f32_16x16x32_bf16 v[12:15], v[180:183], v[136:139], v[12:15]
    v_rcp_f32 v125, v125
    v_mfma_f32_16x16x32_bf16 v[16:19], v[184:187], v[136:139], v[16:19]
    v_rcp_f32 v126, v126
    v_mfma_f32_16x16x32_bf16 v[20:23], v[188:191], v[136:139], v[20:23]
    s_waitcnt lgkmcnt(0)
    v_rcp_f32 v127, v127
    ds_read_b64_tr_b16 v[168:169], v218 offset:0
    ds_read_b64_tr_b16 v[170:171], v218 offset:3072
    ds_read_b64_tr_b16 v[172:173], v219 offset:0
    ds_read_b64_tr_b16 v[174:175], v219 offset:3072
    ds_read_b64_tr_b16 v[176:177], v218 offset:64
    ds_read_b64_tr_b16 v[178:179], v218 offset:3136
    ds_read_b64_tr_b16 v[180:181], v219 offset:64
    ds_read_b64_tr_b16 v[182:183], v219 offset:3136
    ds_read_b64_tr_b16 v[184:185], v218 offset:128
    ds_read_b64_tr_b16 v[186:187], v218 offset:3200
    ds_read_b64_tr_b16 v[188:189], v219 offset:128
    ds_read_b64_tr_b16 v[190:191], v219 offset:3200
    v_pk_mul_f32 v[120:121], v[88:89], v[120:121]
    v_pk_mul_f32 v[122:123], v[90:91], v[122:123]
    v_pk_mul_f32 v[124:125], v[92:93], v[124:125]
    v_pk_mul_f32 v[126:127], v[94:95], v[126:127]
    v_cvt_pk_bf16_f32 v136, v120, v121
    v_cvt_pk_bf16_f32 v137, v122, v123
    v_cvt_pk_bf16_f32 v138, v124, v125
    v_cvt_pk_bf16_f32 v139, v126, v127
    s_waitcnt lgkmcnt(0)
    s_nop 0
    v_mfma_f32_16x16x32_bf16 v[0:3], v[168:171], v[136:139], v[0:3]
    v_mfma_f32_16x16x32_bf16 v[4:7], v[172:175], v[136:139], v[4:7]
    v_mfma_f32_16x16x32_bf16 v[8:11], v[176:179], v[136:139], v[8:11]
    v_mfma_f32_16x16x32_bf16 v[12:15], v[180:183], v[136:139], v[12:15]
    v_mfma_f32_16x16x32_bf16 v[16:19], v[184:187], v[136:139], v[16:19]
    v_mfma_f32_16x16x32_bf16 v[20:23], v[188:191], v[136:139], v[20:23]
    s_nop 2
    v_cvt_pk_bf16_f32 v72, v0, v1
    v_cvt_pk_bf16_f32 v73, v2, v3
    v_cvt_pk_bf16_f32 v74, v4, v5
    v_cvt_pk_bf16_f32 v75, v6, v7
    v_cvt_pk_bf16_f32 v76, v8, v9
    v_cvt_pk_bf16_f32 v77, v10, v11
    v_cvt_pk_bf16_f32 v78, v12, v13
    v_cvt_pk_bf16_f32 v79, v14, v15
    v_cvt_pk_bf16_f32 v80, v16, v17
    v_cvt_pk_bf16_f32 v81, v18, v19
    v_cvt_pk_bf16_f32 v82, v20, v21
    v_cvt_pk_bf16_f32 v83, v22, v23
    ds_write_b64 v246, v[72:73] offset:0
    ds_write_b64 v247, v[74:75] offset:0
    ds_write_b64 v246, v[76:77] offset:64
    ds_write_b64 v247, v[78:79] offset:64
    ds_write_b64 v246, v[80:81] offset:128
    ds_write_b64 v247, v[82:83] offset:128
    ds_read_b128 v[104:107], v240
    ds_read_b128 v[108:111], v241
    ds_read_b128 v[112:115], v242
    s_waitcnt lgkmcnt(2)
    buffer_store_dwordx4 v[104:107], v244, s[36:39], s60 offen offset:0 sc1
    s_waitcnt lgkmcnt(1)
    buffer_store_dwordx4 v[108:111], v244, s[36:39], s60 offen offset:1024 sc1
    s_waitcnt lgkmcnt(0)
    buffer_store_dwordx4 v[112:115], v244, s[36:39], s60 offen offset:2048 sc1
    s_endpgm
L_slow18:
    ds_read_b32 v249, v243 offset:0
    s_waitcnt lgkmcnt(0)
    v_cmp_gt_u32 vcc, 2, v249
    s_cbranch_vccnz L_slow18
    s_branch L_back18
L_slow19:
    ds_read_b32 v249, v243 offset:16
    s_waitcnt lgkmcnt(0)
    v_cmp_gt_u32 vcc, 3, v249
    s_cbranch_vccnz L_slow19
    s_branch L_back19
L_slow20:
    ds_read_b32 v249, v243 offset:0
    s_waitcnt lgkmcnt(0)
    v_cmp_gt_u32 vcc, 3, v249
    s_cbranch_vccnz L_slow20
    s_branch L_back20
L_slow21:
    ds_read_b32 v249, v243 offset:16
    s_waitcnt lgkmcnt(0)
    v_cmp_gt_u32 vcc, 6, v249
    s_cbranch_vccnz L_slow21
    s_branch L_back21
L_slow22:
    ds_read_b32 v249, v243 offset:16
    s_waitcnt lgkmcnt(0)
    v_cmp_gt_u32 vcc, 7, v249
    s_cbranch_vccnz L_slow22
    s_branch L_back22
L_slow23:
    ds_read_b32 v249, v243 offset:16
    s_waitcnt lgkmcnt(0)
    v_cmp_gt_u32 vcc, 8, v249
    s_cbranch_vccnz L_slow23
    s_branch L_back23
L_end:
    s_endpgm
.section .rodata,"a"
.p2align 6
.amdhsa_kernel standalone__modern_conv_block_replknet__vision_kernel
  .amdhsa_next_free_vgpr 256
  .amdhsa_next_free_sgpr 102
  .amdhsa_accum_offset 256
  .amdhsa_group_segment_fixed_size 0
  .amdhsa_kernarg_size 64
  .amdhsa_user_sgpr_count 2
  .amdhsa_user_sgpr_kernarg_segment_ptr 1
  .amdhsa_system_sgpr_workgroup_id_x 1
.end_amdhsa_kernel
```
